```python
import torch

def _softmax(x, axis=-1):
    return torch.softmax(x, dim=axis)
def _gelu(x):
    return torch.nn.functional.gelu(x, approximate="tanh")
def _silu(x):
    return torch.nn.functional.silu(x)
def _sigmoid(x):
    return torch.sigmoid(x)
def _layernorm(x, axis=-1, eps=1e-5):
    m = x.mean(dim=axis, keepdim=True)
    v = x.var(dim=axis, keepdim=True, unbiased=False)
    return (x - m) / torch.sqrt(v + eps)
def _scatter_add(tgt, idx, src, axis=0):
    return tgt.clone().index_add_(axis, idx, src)
def _segment_sum(src, seg, n):
    out = torch.zeros((n,) + src.shape[1:], dtype=src.dtype)
    return out.index_add_(0, seg, src)
def _pad(x, pw):
    flat = tuple(v for pair in reversed(pw) for v in pair)
    return torch.nn.functional.pad(x, flat)

kernel_name = 'standalone__linear_kernel_rfa__prompt'

def setup_inputs():

    _w = (lambda a: (lambda t: t.to(torch.bfloat16) if t.is_floating_point() else t)(torch.as_tensor(a)))
    B, H, Sq, Sk, D, M = 1, 16, 2048, 2048, 256, 64
    return {
        "q": _w((lambda *s: torch.randn(*s, dtype=torch.bfloat16) * 0.05)(B, H, Sq, D)),
        "k": _w((lambda *s: torch.randn(*s, dtype=torch.bfloat16) * 0.8)(B, H, Sk, D)),
        "v": _w((lambda *s: torch.randn(*s, dtype=torch.bfloat16) * 0.8)(B, H, Sk, D)),
        "omega": _w((lambda *s: torch.randn(*s, dtype=torch.bfloat16) * 0.8)(M, D)),
    }

def reference(q, k, v, omega):
    d = q.shape[-1]
    m = omega.shape[0]
    scale = float(d) ** -0.25
    qs = q * scale
    ks = k * scale
    q_proj = torch.einsum("bhsd,md->bhsm", qs, omega)
    k_proj = torch.einsum("bhsd,md->bhsm", ks, omega)
    q_sq = 0.5 * torch.einsum("bhsd,bhsd->bhs", qs, qs)[..., None]
    k_sq = 0.5 * torch.einsum("bhsd,bhsd->bhs", ks, ks)[..., None]
    inv_sqrt_m = float(m) ** -0.5
    phi_q = torch.exp(q_proj - q_sq) * inv_sqrt_m + 1e-6
    phi_k = torch.exp(k_proj - k_sq) * inv_sqrt_m + 1e-6
    kv = torch.einsum("bhsm,bhsd->bhmd", phi_k, v)
    z  = torch.einsum("bhsm->bhm", phi_k)
    num = torch.einsum("bhqm,bhmd->bhqd", phi_q, kv)
    den = torch.einsum("bhqm,bhm->bhq", phi_q, z)[..., None] + 1e-6
    return num / den
```

```asm
; @launch grid=(256,1,1) block=(512,1,1) lds=149504
.amdgcn_target "amdgcn-amd-amdhsa--gfx950"
.text
.globl standalone__linear_kernel_rfa__prompt_kernel
.p2align 8
.type standalone__linear_kernel_rfa__prompt_kernel,@function
standalone__linear_kernel_rfa__prompt_kernel:
  s_cmp_ge_u32 s2, 256
  s_cbranch_scc1 L_end
  s_load_dwordx4 s[44:47], s[0:1], 16
  s_load_dwordx2 s[52:53], s[0:1], 48
  s_load_dwordx4 s[40:43], s[0:1], 0
  s_load_dwordx4 s[48:51], s[0:1], 32
  v_and_b32 v1, 63, v0
  v_lshrrev_b32 v2, 6, v0
  s_and_b32 s36, s2, 15
  v_readfirstlane_b32 s38, v2
  s_lshr_b32 s37, s2, 4
  s_lshl_b32 s39, s36, 20
  s_lshl_b32 s4, s37, 16
  s_add_u32 s39, s39, s4
  s_lshl_b32 s98, s36, 8
  s_add_u32 s99, s98, 10551296
  s_add_u32 s98, s98, 10485760
  s_mov_b32 s26, 268435456
  s_mov_b32 s27, 0x20000
  s_cmp_ge_u32 s38, 4
  s_cbranch_scc1 L_qteam
  s_setprio 1
  v_lshrrev_b32 v6, 5, v1
  v_and_b32 v7, 31, v1
  v_xor_b32 v8, v7, v6
  v_lshlrev_b32 v8, 4, v8
  v_lshlrev_b32 v9, 9, v6
  v_add_u32 v4, v9, v8
  v_lshlrev_b32 v3, 9, v7
  v_lshlrev_b32 v6, 4, v6
  v_add_u32 v3, v3, v6
  s_lshl_b32 s4, s38, 13
  s_add_u32 s60, s4, 2048
  s_lshl_b32 s5, s38, 14
  s_add_u32 s58, s39, s5
  s_mov_b32 s30, 32768
  s_mov_b32 s31, 0x20000
  s_mov_b32 s14, 16777216
  s_mov_b32 s15, 0x20000
  s_waitcnt lgkmcnt(0)
  s_mov_b32 s28, s46
  s_mov_b32 s29, s47
  s_mov_b32 s12, s42
  s_mov_b32 s13, s43
  s_mov_b32 m0, s60
  s_add_u32 s60, s60, 1024
  buffer_load_dwordx4 v4, s[28:31], s4 offen lds
  s_add_u32 s4, s4, 1024
  s_mov_b32 m0, s60
  v_xor_b32 v8, 32, v4
  s_add_u32 s60, s60, 1024
  buffer_load_dwordx4 v8, s[28:31], s4 offen lds
  s_add_u32 s4, s4, 1024
  s_mov_b32 m0, s60
  v_xor_b32 v8, 64, v4
  s_add_u32 s60, s60, 1024
  buffer_load_dwordx4 v8, s[28:31], s4 offen lds
  s_add_u32 s4, s4, 1024
  s_mov_b32 m0, s60
  v_xor_b32 v8, 96, v4
  s_add_u32 s60, s60, 1024
  buffer_load_dwordx4 v8, s[28:31], s4 offen lds
  s_add_u32 s4, s4, 1024
  s_mov_b32 m0, s60
  v_xor_b32 v8, 128, v4
  s_add_u32 s60, s60, 1024
  buffer_load_dwordx4 v8, s[28:31], s4 offen lds
  s_add_u32 s4, s4, 1024
  s_mov_b32 m0, s60
  v_xor_b32 v8, 160, v4
  s_add_u32 s60, s60, 1024
  buffer_load_dwordx4 v8, s[28:31], s4 offen lds
  s_add_u32 s4, s4, 1024
  s_mov_b32 m0, s60
  v_xor_b32 v8, 192, v4
  s_add_u32 s60, s60, 1024
  buffer_load_dwordx4 v8, s[28:31], s4 offen lds
  s_add_u32 s4, s4, 1024
  s_mov_b32 m0, s60
  v_xor_b32 v8, 224, v4
  s_add_u32 s60, s60, 1024
  buffer_load_dwordx4 v8, s[28:31], s4 offen lds
  s_add_u32 s4, s4, 1024
  buffer_load_dwordx4 v[16:19], v3, s[12:15], s58 offen offset:0
  buffer_load_dwordx4 v[20:23], v3, s[12:15], s58 offen offset:32
  buffer_load_dwordx4 v[24:27], v3, s[12:15], s58 offen offset:64
  buffer_load_dwordx4 v[28:31], v3, s[12:15], s58 offen offset:96
  buffer_load_dwordx4 v[32:35], v3, s[12:15], s58 offen offset:128
  buffer_load_dwordx4 v[36:39], v3, s[12:15], s58 offen offset:160
  buffer_load_dwordx4 v[40:43], v3, s[12:15], s58 offen offset:192
  buffer_load_dwordx4 v[44:47], v3, s[12:15], s58 offen offset:224
  buffer_load_dwordx4 v[48:51], v3, s[12:15], s58 offen offset:256
  buffer_load_dwordx4 v[52:55], v3, s[12:15], s58 offen offset:288
  buffer_load_dwordx4 v[56:59], v3, s[12:15], s58 offen offset:320
  buffer_load_dwordx4 v[60:63], v3, s[12:15], s58 offen offset:352
  buffer_load_dwordx4 v[64:67], v3, s[12:15], s58 offen offset:384
  buffer_load_dwordx4 v[68:71], v3, s[12:15], s58 offen offset:416
  buffer_load_dwordx4 v[72:75], v3, s[12:15], s58 offen offset:448
  buffer_load_dwordx4 v[76:79], v3, s[12:15], s58 offen offset:480
  s_mov_b32 s24, s52
  s_mov_b32 s25, s53
  s_add_u32 s0, s52, s98
  s_addc_u32 s1, s53, 0
  s_mov_b32 s32, s50
  s_mov_b32 s33, s51
  s_mov_b32 s34, 256
  s_mov_b32 s35, 0x20000
  s_mov_b32 s20, s48
  s_mov_b32 s21, s49
  s_mov_b32 s22, 16777216
  s_mov_b32 s23, 0x20000
  s_getreg_b32 s95, hwreg(HW_REG_XCC_ID, 0, 4)
  s_mov_b32 s61, 0x3e800000
  s_mov_b32 s62, 0x3fb8aa3b
  v_lshlrev_b32 v5, 4, v1
  v_and_b32 v6, 31, v1
  v_lshlrev_b32 v160, 9, v6
  v_and_b32 v6, 15, v1
  v_lshrrev_b32 v7, 5, v1
  v_xor_b32 v6, v6, v7
  v_lshlrev_b32 v6, 4, v6
  v_add_u32 v160, v160, v6
  v_add_u32 v160, 2048, v160
  v_xor_b32 v161, 32, v160
  v_xor_b32 v162, 64, v160
  v_xor_b32 v163, 96, v160
  v_xor_b32 v164, 128, v160
  v_xor_b32 v165, 160, v160
  v_xor_b32 v166, 192, v160
  v_xor_b32 v167, 224, v160
  v_mov_b32 v152, 0
  v_mov_b32 v153, 0
  v_mov_b32 v154, 0
  v_mov_b32 v155, 0
  v_mov_b32 v156, 0xc0400000
  s_waitcnt vmcnt(16)
  s_barrier
  ds_read_b128 a[0:3], v160 offset:0
  ds_read_b128 a[4:7], v160 offset:16384
  ds_read_b128 a[8:11], v161 offset:0
  ds_read_b128 a[12:15], v161 offset:16384
  s_waitcnt vmcnt(15) lgkmcnt(2)
  v_mfma_f32_32x32x16_bf16 v[80:95], v[16:19], a[0:3], 0
  v_mfma_f32_32x32x16_bf16 v[96:111], v[16:19], a[4:7], 0
  v_dot2c_f32_bf16 v152, v16, v16
  v_dot2c_f32_bf16 v153, v17, v17
  v_dot2c_f32_bf16 v154, v18, v18
  v_dot2c_f32_bf16 v155, v19, v19
  ds_read_b128 a[0:3], v162 offset:0
  ds_read_b128 a[4:7], v162 offset:16384
  s_waitcnt vmcnt(14) lgkmcnt(2)
  v_mfma_f32_32x32x16_bf16 v[80:95], v[20:23], a[8:11], v[80:95]
  v_mfma_f32_32x32x16_bf16 v[96:111], v[20:23], a[12:15], v[96:111]
  v_dot2c_f32_bf16 v152, v20, v20
  v_dot2c_f32_bf16 v153, v21, v21
  v_dot2c_f32_bf16 v154, v22, v22
  v_dot2c_f32_bf16 v155, v23, v23
  ds_read_b128 a[8:11], v163 offset:0
  ds_read_b128 a[12:15], v163 offset:16384
  s_waitcnt vmcnt(13) lgkmcnt(2)
  v_mfma_f32_32x32x16_bf16 v[80:95], v[24:27], a[0:3], v[80:95]
  v_mfma_f32_32x32x16_bf16 v[96:111], v[24:27], a[4:7], v[96:111]
  v_dot2c_f32_bf16 v152, v24, v24
  v_dot2c_f32_bf16 v153, v25, v25
  v_dot2c_f32_bf16 v154, v26, v26
  v_dot2c_f32_bf16 v155, v27, v27
  ds_read_b128 a[0:3], v164 offset:0
  ds_read_b128 a[4:7], v164 offset:16384
  s_waitcnt vmcnt(12) lgkmcnt(2)
  v_mfma_f32_32x32x16_bf16 v[80:95], v[28:31], a[8:11], v[80:95]
  v_mfma_f32_32x32x16_bf16 v[96:111], v[28:31], a[12:15], v[96:111]
  v_dot2c_f32_bf16 v152, v28, v28
  v_dot2c_f32_bf16 v153, v29, v29
  v_dot2c_f32_bf16 v154, v30, v30
  v_dot2c_f32_bf16 v155, v31, v31
  ds_read_b128 a[8:11], v165 offset:0
  ds_read_b128 a[12:15], v165 offset:16384
  s_waitcnt vmcnt(11) lgkmcnt(2)
  v_mfma_f32_32x32x16_bf16 v[80:95], v[32:35], a[0:3], v[80:95]
  v_mfma_f32_32x32x16_bf16 v[96:111], v[32:35], a[4:7], v[96:111]
  v_dot2c_f32_bf16 v152, v32, v32
  v_dot2c_f32_bf16 v153, v33, v33
  v_dot2c_f32_bf16 v154, v34, v34
  v_dot2c_f32_bf16 v155, v35, v35
  ds_read_b128 a[0:3], v166 offset:0
  ds_read_b128 a[4:7], v166 offset:16384
  s_waitcnt vmcnt(10) lgkmcnt(2)
  v_mfma_f32_32x32x16_bf16 v[80:95], v[36:39], a[8:11], v[80:95]
  v_mfma_f32_32x32x16_bf16 v[96:111], v[36:39], a[12:15], v[96:111]
  v_dot2c_f32_bf16 v152, v36, v36
  v_dot2c_f32_bf16 v153, v37, v37
  v_dot2c_f32_bf16 v154, v38, v38
  v_dot2c_f32_bf16 v155, v39, v39
  ds_read_b128 a[8:11], v167 offset:0
  ds_read_b128 a[12:15], v167 offset:16384
  s_waitcnt vmcnt(9) lgkmcnt(2)
  v_mfma_f32_32x32x16_bf16 v[80:95], v[40:43], a[0:3], v[80:95]
  v_mfma_f32_32x32x16_bf16 v[96:111], v[40:43], a[4:7], v[96:111]
  v_dot2c_f32_bf16 v152, v40, v40
  v_dot2c_f32_bf16 v153, v41, v41
  v_dot2c_f32_bf16 v154, v42, v42
  v_dot2c_f32_bf16 v155, v43, v43
  ds_read_b128 a[0:3], v160 offset:256
  ds_read_b128 a[4:7], v160 offset:16640
  s_waitcnt vmcnt(8) lgkmcnt(2)
  v_mfma_f32_32x32x16_bf16 v[80:95], v[44:47], a[8:11], v[80:95]
  v_mfma_f32_32x32x16_bf16 v[96:111], v[44:47], a[12:15], v[96:111]
  v_dot2c_f32_bf16 v152, v44, v44
  v_dot2c_f32_bf16 v153, v45, v45
  v_dot2c_f32_bf16 v154, v46, v46
  v_dot2c_f32_bf16 v155, v47, v47
  ds_read_b128 a[8:11], v161 offset:256
  ds_read_b128 a[12:15], v161 offset:16640
  s_waitcnt vmcnt(7) lgkmcnt(2)
  v_mfma_f32_32x32x16_bf16 v[80:95], v[48:51], a[0:3], v[80:95]
  v_mfma_f32_32x32x16_bf16 v[96:111], v[48:51], a[4:7], v[96:111]
  v_dot2c_f32_bf16 v152, v48, v48
  v_dot2c_f32_bf16 v153, v49, v49
  v_dot2c_f32_bf16 v154, v50, v50
  v_dot2c_f32_bf16 v155, v51, v51
  ds_read_b128 a[0:3], v162 offset:256
  ds_read_b128 a[4:7], v162 offset:16640
  s_waitcnt vmcnt(6) lgkmcnt(2)
  v_mfma_f32_32x32x16_bf16 v[80:95], v[52:55], a[8:11], v[80:95]
  v_mfma_f32_32x32x16_bf16 v[96:111], v[52:55], a[12:15], v[96:111]
  v_dot2c_f32_bf16 v152, v52, v52
  v_dot2c_f32_bf16 v153, v53, v53
  v_dot2c_f32_bf16 v154, v54, v54
  v_dot2c_f32_bf16 v155, v55, v55
  ds_read_b128 a[8:11], v163 offset:256
  ds_read_b128 a[12:15], v163 offset:16640
  s_waitcnt vmcnt(5) lgkmcnt(2)
  v_mfma_f32_32x32x16_bf16 v[80:95], v[56:59], a[0:3], v[80:95]
  v_mfma_f32_32x32x16_bf16 v[96:111], v[56:59], a[4:7], v[96:111]
  v_dot2c_f32_bf16 v152, v56, v56
  v_dot2c_f32_bf16 v153, v57, v57
  v_dot2c_f32_bf16 v154, v58, v58
  v_dot2c_f32_bf16 v155, v59, v59
  ds_read_b128 a[0:3], v164 offset:256
  ds_read_b128 a[4:7], v164 offset:16640
  s_waitcnt vmcnt(4) lgkmcnt(2)
  v_mfma_f32_32x32x16_bf16 v[80:95], v[60:63], a[8:11], v[80:95]
  v_mfma_f32_32x32x16_bf16 v[96:111], v[60:63], a[12:15], v[96:111]
  v_dot2c_f32_bf16 v152, v60, v60
  v_dot2c_f32_bf16 v153, v61, v61
  v_dot2c_f32_bf16 v154, v62, v62
  v_dot2c_f32_bf16 v155, v63, v63
  ds_read_b128 a[8:11], v165 offset:256
  ds_read_b128 a[12:15], v165 offset:16640
  s_waitcnt vmcnt(3) lgkmcnt(2)
  v_mfma_f32_32x32x16_bf16 v[80:95], v[64:67], a[0:3], v[80:95]
  v_mfma_f32_32x32x16_bf16 v[96:111], v[64:67], a[4:7], v[96:111]
  v_dot2c_f32_bf16 v152, v64, v64
  v_dot2c_f32_bf16 v153, v65, v65
  v_dot2c_f32_bf16 v154, v66, v66
  v_dot2c_f32_bf16 v155, v67, v67
  ds_read_b128 a[0:3], v166 offset:256
  ds_read_b128 a[4:7], v166 offset:16640
  s_waitcnt vmcnt(2) lgkmcnt(2)
  v_mfma_f32_32x32x16_bf16 v[80:95], v[68:71], a[8:11], v[80:95]
  v_mfma_f32_32x32x16_bf16 v[96:111], v[68:71], a[12:15], v[96:111]
  v_dot2c_f32_bf16 v152, v68, v68
  v_dot2c_f32_bf16 v153, v69, v69
  v_dot2c_f32_bf16 v154, v70, v70
  v_dot2c_f32_bf16 v155, v71, v71
  ds_read_b128 a[8:11], v167 offset:256
  ds_read_b128 a[12:15], v167 offset:16640
  s_waitcnt vmcnt(1) lgkmcnt(2)
  v_mfma_f32_32x32x16_bf16 v[80:95], v[72:75], a[0:3], v[80:95]
  v_mfma_f32_32x32x16_bf16 v[96:111], v[72:75], a[4:7], v[96:111]
  v_dot2c_f32_bf16 v152, v72, v72
  v_dot2c_f32_bf16 v153, v73, v73
  v_dot2c_f32_bf16 v154, v74, v74
  v_dot2c_f32_bf16 v155, v75, v75
  s_waitcnt vmcnt(0) lgkmcnt(0)
  v_mfma_f32_32x32x16_bf16 v[80:95], v[76:79], a[8:11], v[80:95]
  v_mfma_f32_32x32x16_bf16 v[96:111], v[76:79], a[12:15], v[96:111]
  v_dot2c_f32_bf16 v152, v76, v76
  v_dot2c_f32_bf16 v153, v77, v77
  v_dot2c_f32_bf16 v154, v78, v78
  v_dot2c_f32_bf16 v155, v79, v79
  s_nop 2
  v_add_f32 v152, v152, v153
  v_add_f32 v154, v154, v155
  v_add_f32 v152, v152, v154
  v_mov_b32 v144, v152
  s_nop 1
  v_permlane32_swap_b32 v144, v152
  s_nop 1
  v_add_f32 v152, v152, v144
  v_mul_f32 v152, 0x3d800000, v152
  v_cvt_pk_bf16_f32 v152, 0, v152
  v_mul_f32 v152, 0.5, v152
  s_lshl_b32 s4, s38, 7
  s_add_u32 s4, s4, 128
  v_and_b32 v8, 31, v1
  v_lshlrev_b32 v8, 2, v8
  v_add_u32 v8, s4, v8
  ds_write_b32 v8, v152
  v_lshrrev_b32 v9, 5, v1
  v_lshlrev_b32 v9, 4, v9
  v_add_u32 v9, s4, v9
  ds_read_b128 v[112:115], v9 offset:0
  ds_read_b128 v[116:119], v9 offset:32
  ds_read_b128 v[120:123], v9 offset:64
  ds_read_b128 v[124:127], v9 offset:96
  s_lshl_b32 s4, s38, 11
  v_add_u32 v10, s4, v5
  v_mov_b32 v11, 0x3f803f80
  v_mov_b32 v153, 0
  v_mov_b32 v154, 0
  s_waitcnt lgkmcnt(0)
  v_cvt_pk_bf16_f32 v144, 0, v80
  v_cvt_pk_bf16_f32 v145, 0, v81
  v_cvt_pk_bf16_f32 v146, 0, v82
  v_cvt_pk_bf16_f32 v147, 0, v83
  v_cvt_pk_bf16_f32 v148, 0, v84
  v_cvt_pk_bf16_f32 v149, 0, v85
  v_cvt_pk_bf16_f32 v150, 0, v86
  v_cvt_pk_bf16_f32 v151, 0, v87
  v_fma_f32 v144, v144, s61, -v112
  v_fma_f32 v145, v145, s61, -v113
  v_fma_f32 v146, v146, s61, -v114
  v_fma_f32 v147, v147, s61, -v115
  v_fma_f32 v148, v148, s61, -v116
  v_fma_f32 v149, v149, s61, -v117
  v_fma_f32 v150, v150, s61, -v118
  v_fma_f32 v151, v151, s61, -v119
  v_cvt_pk_bf16_f32 v144, 0, v144
  v_cvt_pk_bf16_f32 v145, 0, v145
  v_cvt_pk_bf16_f32 v146, 0, v146
  v_cvt_pk_bf16_f32 v147, 0, v147
  v_cvt_pk_bf16_f32 v148, 0, v148
  v_cvt_pk_bf16_f32 v149, 0, v149
  v_cvt_pk_bf16_f32 v150, 0, v150
  v_cvt_pk_bf16_f32 v151, 0, v151
  v_fma_f32 v144, v144, s62, v156
  v_fma_f32 v145, v145, s62, v156
  v_fma_f32 v146, v146, s62, v156
  v_fma_f32 v147, v147, s62, v156
  v_fma_f32 v148, v148, s62, v156
  v_fma_f32 v149, v149, s62, v156
  v_fma_f32 v150, v150, s62, v156
  v_fma_f32 v151, v151, s62, v156
  v_exp_f32 v144, v144
  v_exp_f32 v145, v145
  v_exp_f32 v146, v146
  v_exp_f32 v147, v147
  v_exp_f32 v148, v148
  v_exp_f32 v149, v149
  v_exp_f32 v150, v150
  v_exp_f32 v151, v151
  s_nop 0
  v_add_f32 v144, 0x358637bd, v144
  v_add_f32 v145, 0x358637bd, v145
  v_add_f32 v146, 0x358637bd, v146
  v_add_f32 v147, 0x358637bd, v147
  v_add_f32 v148, 0x358637bd, v148
  v_add_f32 v149, 0x358637bd, v149
  v_add_f32 v150, 0x358637bd, v150
  v_add_f32 v151, 0x358637bd, v151
  v_cvt_pk_bf16_f32 v128, v144, v145
  v_cvt_pk_bf16_f32 v129, v146, v147
  v_cvt_pk_bf16_f32 v130, v148, v149
  v_cvt_pk_bf16_f32 v131, v150, v151
  ds_write_b128 v10, v[128:131] offset:34816
  v_dot2c_f32_bf16 v153, v128, v11
  v_dot2c_f32_bf16 v153, v129, v11
  v_dot2c_f32_bf16 v153, v130, v11
  v_dot2c_f32_bf16 v153, v131, v11
  v_cvt_pk_bf16_f32 v144, 0, v88
  v_cvt_pk_bf16_f32 v145, 0, v89
  v_cvt_pk_bf16_f32 v146, 0, v90
  v_cvt_pk_bf16_f32 v147, 0, v91
  v_cvt_pk_bf16_f32 v148, 0, v92
  v_cvt_pk_bf16_f32 v149, 0, v93
  v_cvt_pk_bf16_f32 v150, 0, v94
  v_cvt_pk_bf16_f32 v151, 0, v95
  v_fma_f32 v144, v144, s61, -v120
  v_fma_f32 v145, v145, s61, -v121
  v_fma_f32 v146, v146, s61, -v122
  v_fma_f32 v147, v147, s61, -v123
  v_fma_f32 v148, v148, s61, -v124
  v_fma_f32 v149, v149, s61, -v125
  v_fma_f32 v150, v150, s61, -v126
  v_fma_f32 v151, v151, s61, -v127
  v_cvt_pk_bf16_f32 v144, 0, v144
  v_cvt_pk_bf16_f32 v145, 0, v145
  v_cvt_pk_bf16_f32 v146, 0, v146
  v_cvt_pk_bf16_f32 v147, 0, v147
  v_cvt_pk_bf16_f32 v148, 0, v148
  v_cvt_pk_bf16_f32 v149, 0, v149
  v_cvt_pk_bf16_f32 v150, 0, v150
  v_cvt_pk_bf16_f32 v151, 0, v151
  v_fma_f32 v144, v144, s62, v156
  v_fma_f32 v145, v145, s62, v156
  v_fma_f32 v146, v146, s62, v156
  v_fma_f32 v147, v147, s62, v156
  v_fma_f32 v148, v148, s62, v156
  v_fma_f32 v149, v149, s62, v156
  v_fma_f32 v150, v150, s62, v156
  v_fma_f32 v151, v151, s62, v156
  v_exp_f32 v144, v144
  v_exp_f32 v145, v145
  v_exp_f32 v146, v146
  v_exp_f32 v147, v147
  v_exp_f32 v148, v148
  v_exp_f32 v149, v149
  v_exp_f32 v150, v150
  v_exp_f32 v151, v151
  s_nop 0
  v_add_f32 v144, 0x358637bd, v144
  v_add_f32 v145, 0x358637bd, v145
  v_add_f32 v146, 0x358637bd, v146
  v_add_f32 v147, 0x358637bd, v147
  v_add_f32 v148, 0x358637bd, v148
  v_add_f32 v149, 0x358637bd, v149
  v_add_f32 v150, 0x358637bd, v150
  v_add_f32 v151, 0x358637bd, v151
  v_cvt_pk_bf16_f32 v132, v144, v145
  v_cvt_pk_bf16_f32 v133, v146, v147
  v_cvt_pk_bf16_f32 v134, v148, v149
  v_cvt_pk_bf16_f32 v135, v150, v151
  ds_write_b128 v10, v[132:135] offset:35840
  v_dot2c_f32_bf16 v153, v132, v11
  v_dot2c_f32_bf16 v153, v133, v11
  v_dot2c_f32_bf16 v153, v134, v11
  v_dot2c_f32_bf16 v153, v135, v11
  v_cvt_pk_bf16_f32 v144, 0, v96
  v_cvt_pk_bf16_f32 v145, 0, v97
  v_cvt_pk_bf16_f32 v146, 0, v98
  v_cvt_pk_bf16_f32 v147, 0, v99
  v_cvt_pk_bf16_f32 v148, 0, v100
  v_cvt_pk_bf16_f32 v149, 0, v101
  v_cvt_pk_bf16_f32 v150, 0, v102
  v_cvt_pk_bf16_f32 v151, 0, v103
  v_fma_f32 v144, v144, s61, -v112
  v_fma_f32 v145, v145, s61, -v113
  v_fma_f32 v146, v146, s61, -v114
  v_fma_f32 v147, v147, s61, -v115
  v_fma_f32 v148, v148, s61, -v116
  v_fma_f32 v149, v149, s61, -v117
  v_fma_f32 v150, v150, s61, -v118
  v_fma_f32 v151, v151, s61, -v119
  v_cvt_pk_bf16_f32 v144, 0, v144
  v_cvt_pk_bf16_f32 v145, 0, v145
  v_cvt_pk_bf16_f32 v146, 0, v146
  v_cvt_pk_bf16_f32 v147, 0, v147
  v_cvt_pk_bf16_f32 v148, 0, v148
  v_cvt_pk_bf16_f32 v149, 0, v149
  v_cvt_pk_bf16_f32 v150, 0, v150
  v_cvt_pk_bf16_f32 v151, 0, v151
  v_fma_f32 v144, v144, s62, v156
  v_fma_f32 v145, v145, s62, v156
  v_fma_f32 v146, v146, s62, v156
  v_fma_f32 v147, v147, s62, v156
  v_fma_f32 v148, v148, s62, v156
  v_fma_f32 v149, v149, s62, v156
  v_fma_f32 v150, v150, s62, v156
  v_fma_f32 v151, v151, s62, v156
  v_exp_f32 v144, v144
  v_exp_f32 v145, v145
  v_exp_f32 v146, v146
  v_exp_f32 v147, v147
  v_exp_f32 v148, v148
  v_exp_f32 v149, v149
  v_exp_f32 v150, v150
  v_exp_f32 v151, v151
  s_nop 0
  v_add_f32 v144, 0x358637bd, v144
  v_add_f32 v145, 0x358637bd, v145
  v_add_f32 v146, 0x358637bd, v146
  v_add_f32 v147, 0x358637bd, v147
  v_add_f32 v148, 0x358637bd, v148
  v_add_f32 v149, 0x358637bd, v149
  v_add_f32 v150, 0x358637bd, v150
  v_add_f32 v151, 0x358637bd, v151
  v_cvt_pk_bf16_f32 v136, v144, v145
  v_cvt_pk_bf16_f32 v137, v146, v147
  v_cvt_pk_bf16_f32 v138, v148, v149
  v_cvt_pk_bf16_f32 v139, v150, v151
  ds_write_b128 v10, v[136:139] offset:43008
  v_dot2c_f32_bf16 v154, v136, v11
  v_dot2c_f32_bf16 v154, v137, v11
  v_dot2c_f32_bf16 v154, v138, v11
  v_dot2c_f32_bf16 v154, v139, v11
  v_cvt_pk_bf16_f32 v144, 0, v104
  v_cvt_pk_bf16_f32 v145, 0, v105
  v_cvt_pk_bf16_f32 v146, 0, v106
  v_cvt_pk_bf16_f32 v147, 0, v107
  v_cvt_pk_bf16_f32 v148, 0, v108
  v_cvt_pk_bf16_f32 v149, 0, v109
  v_cvt_pk_bf16_f32 v150, 0, v110
  v_cvt_pk_bf16_f32 v151, 0, v111
  v_fma_f32 v144, v144, s61, -v120
  v_fma_f32 v145, v145, s61, -v121
  v_fma_f32 v146, v146, s61, -v122
  v_fma_f32 v147, v147, s61, -v123
  v_fma_f32 v148, v148, s61, -v124
  v_fma_f32 v149, v149, s61, -v125
  v_fma_f32 v150, v150, s61, -v126
  v_fma_f32 v151, v151, s61, -v127
  v_cvt_pk_bf16_f32 v144, 0, v144
  v_cvt_pk_bf16_f32 v145, 0, v145
  v_cvt_pk_bf16_f32 v146, 0, v146
  v_cvt_pk_bf16_f32 v147, 0, v147
  v_cvt_pk_bf16_f32 v148, 0, v148
  v_cvt_pk_bf16_f32 v149, 0, v149
  v_cvt_pk_bf16_f32 v150, 0, v150
  v_cvt_pk_bf16_f32 v151, 0, v151
  v_fma_f32 v144, v144, s62, v156
  v_fma_f32 v145, v145, s62, v156
  v_fma_f32 v146, v146, s62, v156
  v_fma_f32 v147, v147, s62, v156
  v_fma_f32 v148, v148, s62, v156
  v_fma_f32 v149, v149, s62, v156
  v_fma_f32 v150, v150, s62, v156
  v_fma_f32 v151, v151, s62, v156
  v_exp_f32 v144, v144
  v_exp_f32 v145, v145
  v_exp_f32 v146, v146
  v_exp_f32 v147, v147
  v_exp_f32 v148, v148
  v_exp_f32 v149, v149
  v_exp_f32 v150, v150
  v_exp_f32 v151, v151
  s_nop 0
  v_add_f32 v144, 0x358637bd, v144
  v_add_f32 v145, 0x358637bd, v145
  v_add_f32 v146, 0x358637bd, v146
  v_add_f32 v147, 0x358637bd, v147
  v_add_f32 v148, 0x358637bd, v148
  v_add_f32 v149, 0x358637bd, v149
  v_add_f32 v150, 0x358637bd, v150
  v_add_f32 v151, 0x358637bd, v151
  v_cvt_pk_bf16_f32 v140, v144, v145
  v_cvt_pk_bf16_f32 v141, v146, v147
  v_cvt_pk_bf16_f32 v142, v148, v149
  v_cvt_pk_bf16_f32 v143, v150, v151
  ds_write_b128 v10, v[140:143] offset:44032
  v_dot2c_f32_bf16 v154, v140, v11
  v_dot2c_f32_bf16 v154, v141, v11
  v_dot2c_f32_bf16 v154, v142, v11
  v_dot2c_f32_bf16 v154, v143, v11
  s_nop 2
  v_permlane32_swap_b32 v153, v154
  s_lshl_b32 s4, s38, 8
  s_add_u32 s4, s4, 1024
  v_add_f32 v152, v153, v154
  v_lshlrev_b32 v12, 2, v1
  v_add_u32 v13, s4, v12
  ds_write_b32 v13, v152
  s_waitcnt lgkmcnt(0)
  s_cmp_lg_u32 s38, 1
  s_cbranch_scc1 L_k_nopt
  s_lshl_b32 s56, s36, 15
  s_lshl_b32 s57, s37, 11
  s_add_u32 s56, s56, s57
  s_add_u32 s56, s56, 9437184
  v_lshlrev_b32 v13, 7, v1
  s_mov_b64 exec, 0xffff
  buffer_load_dword v191, v13, s[24:27], s56 offen
  s_lshl_b32 s5, s36, 4
  s_add_u32 s5, s5, s37
  s_lshl_b32 s56, s5, 8
  s_add_u32 s56, s56, 8388608
  s_mov_b64 exec, 3
  buffer_load_dword v191, v13, s[24:27], s56 offen
  s_mov_b64 exec, -1
L_k_nopt:
  v_mov_b32 v14, 768
  v_mov_b32 v15, 1
  s_mov_b64 exec, 1
  ds_add_u32 v14, v15
  s_mov_b64 exec, -1
  v_lshrrev_b32 v6, 5, v1
  v_lshlrev_b32 v6, 2, v6
  v_bfe_u32 v8, v1, 2, 2
  v_add_u32 v6, v6, v8
  v_lshlrev_b32 v6, 7, v6
  v_bfe_u32 v9, v1, 4, 1
  v_lshlrev_b32 v9, 1, v9
  v_bfe_u32 v10, v1, 1, 1
  v_add_u32 v9, v9, v10
  v_bfe_u32 v10, v1, 3, 1
  v_lshlrev_b32 v10, 2, v10
  v_xor_b32 v9, v9, v10
  v_lshlrev_b32 v9, 4, v9
  v_and_b32 v10, 1, v1
  v_lshlrev_b32 v10, 3, v10
  v_add3_u32 v8, v6, v9, v10
  s_lshl_b32 s4, s38, 14
  s_add_u32 s4, s4, 83968
  v_add_u32 v8, s4, v8
  v_xor_b32 v9, 64, v8
  v_and_b32 v6, 3, v1
  s_lshr_b32 s4, s38, 1
  s_lshl_b32 s4, s4, 2
  v_add_u32 v6, s4, v6
  v_lshlrev_b32 v6, 10, v6
  v_lshrrev_b32 v10, 2, v1
  s_and_b32 s4, s38, 1
  s_lshl_b32 s4, s4, 4
  v_add_u32 v10, s4, v10
  v_lshlrev_b32 v10, 4, v10
  v_add_u32 v6, v6, v10
  s_mov_b32 s63, 0
L_ks1:
  ds_read_b32 v13, v14
  s_waitcnt lgkmcnt(0)
  v_readfirstlane_b32 s4, v13
  s_cmp_ge_u32 s4, 4
  s_cbranch_scc1 L_ks1_done
  s_add_u32 s63, s63, 1
  s_cmp_lt_u32 s63, 2097152
  s_cbranch_scc1 L_ks1
  s_branch L_end
L_ks1_done:
  ds_read_b32 v152, v12 offset:1024
  ds_read_b32 v153, v12 offset:1280
  ds_read_b32 v154, v12 offset:1536
  ds_read_b32 v155, v12 offset:1792
  s_lshl_b32 s4, s38, 2
  s_add_u32 s4, s4, 784
  v_mov_b32 v15, s4
  s_mov_b32 s63, 0
L_wva:
  ds_read_b32 v13, v15
  s_waitcnt lgkmcnt(0)
  v_readfirstlane_b32 s4, v13
  s_cmp_ge_u32 s4, 1
  s_cbranch_scc1 L_wva_done
  s_add_u32 s63, s63, 1
  s_cmp_lt_u32 s63, 2097152
  s_cbranch_scc1 L_wva
  s_branch L_end
L_wva_done:
  ds_read_b64_tr_b16 a[24:25], v8 offset:0
  ds_read_b64_tr_b16 a[26:27], v8 offset:1024
  ds_read_b64_tr_b16 a[28:29], v9 offset:0
  ds_read_b64_tr_b16 a[30:31], v9 offset:1024
  ds_read_b128 a[16:19], v5 offset:34816
  ds_read_b128 a[20:23], v5 offset:43008
  ds_read_b64_tr_b16 a[40:41], v8 offset:2048
  ds_read_b64_tr_b16 a[42:43], v8 offset:3072
  ds_read_b64_tr_b16 a[44:45], v9 offset:2048
  ds_read_b64_tr_b16 a[46:47], v9 offset:3072
  ds_read_b128 a[32:35], v5 offset:35840
  ds_read_b128 a[36:39], v5 offset:44032
  s_waitcnt lgkmcnt(6)
  v_mfma_f32_32x32x16_bf16 v[16:31], a[16:19], a[24:27], 0
  v_mfma_f32_32x32x16_bf16 v[32:47], a[16:19], a[28:31], 0
  v_mfma_f32_32x32x16_bf16 v[48:63], a[20:23], a[24:27], 0
  v_mfma_f32_32x32x16_bf16 v[64:79], a[20:23], a[28:31], 0
  v_add_f32 v152, v152, v153
  v_add_f32 v154, v154, v155
  v_add_f32 v152, v152, v154
  ds_read_b64_tr_b16 a[24:25], v8 offset:4096
  ds_read_b64_tr_b16 a[26:27], v8 offset:5120
  ds_read_b64_tr_b16 a[28:29], v9 offset:4096
  ds_read_b64_tr_b16 a[30:31], v9 offset:5120
  ds_read_b128 a[16:19], v5 offset:36864
  ds_read_b128 a[20:23], v5 offset:45056
  s_waitcnt lgkmcnt(6)
  v_mfma_f32_32x32x16_bf16 v[16:31], a[32:35], a[40:43], v[16:31]
  v_mfma_f32_32x32x16_bf16 v[32:47], a[32:35], a[44:47], v[32:47]
  v_mfma_f32_32x32x16_bf16 v[48:63], a[36:39], a[40:43], v[48:63]
  v_mfma_f32_32x32x16_bf16 v[64:79], a[36:39], a[44:47], v[64:79]
  ds_read_b64_tr_b16 a[40:41], v8 offset:6144
  ds_read_b64_tr_b16 a[42:43], v8 offset:7168
  ds_read_b64_tr_b16 a[44:45], v9 offset:6144
  ds_read_b64_tr_b16 a[46:47], v9 offset:7168
  ds_read_b128 a[32:35], v5 offset:37888
  ds_read_b128 a[36:39], v5 offset:46080
  s_waitcnt lgkmcnt(6)
  v_mfma_f32_32x32x16_bf16 v[16:31], a[16:19], a[24:27], v[16:31]
  v_mfma_f32_32x32x16_bf16 v[32:47], a[16:19], a[28:31], v[32:47]
  v_mfma_f32_32x32x16_bf16 v[48:63], a[20:23], a[24:27], v[48:63]
  v_mfma_f32_32x32x16_bf16 v[64:79], a[20:23], a[28:31], v[64:79]
  s_mov_b32 s63, 0
L_wvb:
  ds_read_b32 v13, v15
  s_waitcnt lgkmcnt(0)
  v_readfirstlane_b32 s4, v13
  s_cmp_ge_u32 s4, 2
  s_cbranch_scc1 L_wvb_done
  s_add_u32 s63, s63, 1
  s_cmp_lt_u32 s63, 2097152
  s_cbranch_scc1 L_wvb
  s_branch L_end
L_wvb_done:
  ds_read_b64_tr_b16 a[24:25], v8 offset:8192
  ds_read_b64_tr_b16 a[26:27], v8 offset:9216
  ds_read_b64_tr_b16 a[28:29], v9 offset:8192
  ds_read_b64_tr_b16 a[30:31], v9 offset:9216
  ds_read_b128 a[16:19], v5 offset:38912
  ds_read_b128 a[20:23], v5 offset:47104
  s_waitcnt lgkmcnt(6)
  v_mfma_f32_32x32x16_bf16 v[16:31], a[32:35], a[40:43], v[16:31]
  v_mfma_f32_32x32x16_bf16 v[32:47], a[32:35], a[44:47], v[32:47]
  v_mfma_f32_32x32x16_bf16 v[48:63], a[36:39], a[40:43], v[48:63]
  v_mfma_f32_32x32x16_bf16 v[64:79], a[36:39], a[44:47], v[64:79]
  ds_read_b64_tr_b16 a[40:41], v8 offset:10240
  ds_read_b64_tr_b16 a[42:43], v8 offset:11264
  ds_read_b64_tr_b16 a[44:45], v9 offset:10240
  ds_read_b64_tr_b16 a[46:47], v9 offset:11264
  ds_read_b128 a[32:35], v5 offset:39936
  ds_read_b128 a[36:39], v5 offset:48128
  s_waitcnt lgkmcnt(6)
  v_mfma_f32_32x32x16_bf16 v[16:31], a[16:19], a[24:27], v[16:31]
  v_mfma_f32_32x32x16_bf16 v[32:47], a[16:19], a[28:31], v[32:47]
  v_mfma_f32_32x32x16_bf16 v[48:63], a[20:23], a[24:27], v[48:63]
  v_mfma_f32_32x32x16_bf16 v[64:79], a[20:23], a[28:31], v[64:79]
  ds_read_b64_tr_b16 a[24:25], v8 offset:12288
  ds_read_b64_tr_b16 a[26:27], v8 offset:13312
  ds_read_b64_tr_b16 a[28:29], v9 offset:12288
  ds_read_b64_tr_b16 a[30:31], v9 offset:13312
  ds_read_b128 a[16:19], v5 offset:40960
  ds_read_b128 a[20:23], v5 offset:49152
  s_waitcnt lgkmcnt(6)
  v_mfma_f32_32x32x16_bf16 v[16:31], a[32:35], a[40:43], v[16:31]
  v_mfma_f32_32x32x16_bf16 v[32:47], a[32:35], a[44:47], v[32:47]
  v_mfma_f32_32x32x16_bf16 v[48:63], a[36:39], a[40:43], v[48:63]
  v_mfma_f32_32x32x16_bf16 v[64:79], a[36:39], a[44:47], v[64:79]
  ds_read_b64_tr_b16 a[40:41], v8 offset:14336
  ds_read_b64_tr_b16 a[42:43], v8 offset:15360
  ds_read_b64_tr_b16 a[44:45], v9 offset:14336
  ds_read_b64_tr_b16 a[46:47], v9 offset:15360
  ds_read_b128 a[32:35], v5 offset:41984
  ds_read_b128 a[36:39], v5 offset:50176
  s_waitcnt lgkmcnt(6)
  v_mfma_f32_32x32x16_bf16 v[16:31], a[16:19], a[24:27], v[16:31]
  v_mfma_f32_32x32x16_bf16 v[32:47], a[16:19], a[28:31], v[32:47]
  v_mfma_f32_32x32x16_bf16 v[48:63], a[20:23], a[24:27], v[48:63]
  v_mfma_f32_32x32x16_bf16 v[64:79], a[20:23], a[28:31], v[64:79]
  s_waitcnt lgkmcnt(0)
  v_mfma_f32_32x32x16_bf16 v[16:31], a[32:35], a[40:43], v[16:31]
  v_mfma_f32_32x32x16_bf16 v[32:47], a[32:35], a[44:47], v[32:47]
  v_mfma_f32_32x32x16_bf16 v[48:63], a[36:39], a[40:43], v[48:63]
  v_mfma_f32_32x32x16_bf16 v[64:79], a[36:39], a[44:47], v[64:79]
  v_mov_b32 v14, 784
  s_mov_b32 s63, 0
L_wv0:
  ds_read_b32 v13, v14
  s_waitcnt lgkmcnt(0)
  v_readfirstlane_b32 s4, v13
  s_cmp_ge_u32 s4, 2
  s_cbranch_scc1 L_wv0_done
  s_add_u32 s63, s63, 1
  s_cmp_lt_u32 s63, 2097152
  s_cbranch_scc1 L_wv0
  s_branch L_end
L_wv0_done:
  v_mov_b32 v14, 640
  ds_read_b64 v[158:159], v14
  s_waitcnt lgkmcnt(0)
  s_mov_b32 s63, 0
  v_readfirstlane_b32 s4, v158
  v_readfirstlane_b32 s5, v159
L_k_rdy_chk:
  s_add_u32 s56, s4, s5
  s_and_b32 s57, s56, 0x00ff00ff
  s_lshr_b32 s56, s56, 8
  s_and_b32 s56, s56, 0x00ff00ff
  s_add_u32 s56, s56, s57
  s_lshr_b32 s57, s56, 16
  s_and_b32 s56, s56, 0xffff
  s_add_u32 s56, s56, s57
  s_and_b32 s57, s56, 15
  s_cselect_b32 s57, 0, s56
  s_cmp_lg_u32 s57, 0
  s_cbranch_scc1 L_k_ready
  s_add_u32 s63, s63, 1
  s_cmp_lt_u32 s63, 262144
  s_cbranch_scc0 L_end
  s_lshl_b32 s57, s36, 4
  v_mov_b32 v157, 0
  buffer_load_dwordx2 v[158:159], v157, s[32:35], s57 offen sc1
  s_waitcnt vmcnt(0)
  v_readfirstlane_b32 s4, v158
  v_readfirstlane_b32 s5, v159
  s_branch L_k_rdy_chk
L_k_ready:
  s_lshl_b32 s56, s95, 3
  s_mov_b64 s[96:97], 0xff
  s_lshl_b64 s[96:97], s[96:97], s56
  s_andn2_b32 s4, s4, s96
  s_andn2_b32 s5, s5, s97
  s_or_b32 s4, s4, s5
  s_cmp_eq_u32 s4, 0
  s_cselect_b32 s94, 1, 0
  s_nop 7
  v_cvt_pk_bf16_f32 v80, v16, v17
  v_cvt_pk_bf16_f32 v81, v18, v19
  v_cvt_pk_bf16_f32 v82, v20, v21
  v_cvt_pk_bf16_f32 v83, v22, v23
  v_cvt_pk_bf16_f32 v84, v32, v33
  v_cvt_pk_bf16_f32 v85, v34, v35
  v_cvt_pk_bf16_f32 v86, v36, v37
  v_cvt_pk_bf16_f32 v87, v38, v39
  v_cvt_pk_bf16_f32 v88, v24, v25
  v_cvt_pk_bf16_f32 v89, v26, v27
  v_cvt_pk_bf16_f32 v90, v28, v29
  v_cvt_pk_bf16_f32 v91, v30, v31
  v_cvt_pk_bf16_f32 v92, v40, v41
  v_cvt_pk_bf16_f32 v93, v42, v43
  v_cvt_pk_bf16_f32 v94, v44, v45
  v_cvt_pk_bf16_f32 v95, v46, v47
  v_permlane32_swap_b32 v80, v84
  v_permlane32_swap_b32 v81, v85
  v_permlane32_swap_b32 v82, v86
  v_permlane32_swap_b32 v83, v87
  v_cvt_pk_bf16_f32 v96, v48, v49
  v_cvt_pk_bf16_f32 v97, v50, v51
  v_cvt_pk_bf16_f32 v98, v52, v53
  v_cvt_pk_bf16_f32 v99, v54, v55
  v_cvt_pk_bf16_f32 v100, v64, v65
  v_cvt_pk_bf16_f32 v101, v66, v67
  v_cvt_pk_bf16_f32 v102, v68, v69
  v_cvt_pk_bf16_f32 v103, v70, v71
  v_permlane32_swap_b32 v88, v92
  v_permlane32_swap_b32 v89, v93
  v_permlane32_swap_b32 v90, v94
  v_permlane32_swap_b32 v91, v95
  v_cvt_pk_bf16_f32 v104, v56, v57
  v_cvt_pk_bf16_f32 v105, v58, v59
  v_cvt_pk_bf16_f32 v106, v60, v61
  v_cvt_pk_bf16_f32 v107, v62, v63
  v_cvt_pk_bf16_f32 v108, v72, v73
  v_cvt_pk_bf16_f32 v109, v74, v75
  v_cvt_pk_bf16_f32 v110, v76, v77
  v_cvt_pk_bf16_f32 v111, v78, v79
  v_permlane32_swap_b32 v96, v100
  v_permlane32_swap_b32 v97, v101
  v_permlane32_swap_b32 v98, v102
  v_permlane32_swap_b32 v99, v103
  s_nop 1
  v_permlane32_swap_b32 v104, v108
  v_permlane32_swap_b32 v105, v109
  v_permlane32_swap_b32 v106, v110
  v_permlane32_swap_b32 v107, v111
  s_cmp_eq_u32 s94, 0
  s_cbranch_scc1 L_ps_slow
  s_mov_b32 s56, s39
  buffer_store_dwordx4 v[80:83], v6, s[20:23], s56 offen offset:0
  buffer_store_dwordx4 v[84:87], v6, s[20:23], s56 offen offset:512
  s_add_u32 s56, s56, 8192
  buffer_store_dwordx4 v[88:91], v6, s[20:23], s56 offen offset:0
  buffer_store_dwordx4 v[92:95], v6, s[20:23], s56 offen offset:512
  s_add_u32 s56, s56, 8192
  buffer_store_dwordx4 v[96:99], v6, s[20:23], s56 offen offset:0
  buffer_store_dwordx4 v[100:103], v6, s[20:23], s56 offen offset:512
  s_add_u32 s56, s56, 8192
  buffer_store_dwordx4 v[104:107], v6, s[20:23], s56 offen offset:0
  buffer_store_dwordx4 v[108:111], v6, s[20:23], s56 offen offset:512
  s_cmp_lg_u32 s38, 0
  s_cbranch_scc1 L_k_noz1
  s_lshl_b32 s5, s36, 4
  s_add_u32 s5, s5, s37
  s_lshl_b32 s56, s5, 8
  s_add_u32 s56, s56, 8388608
  buffer_store_dword v152, v12, s[24:27], s56 offen
L_k_noz1:
  s_branch L_ps_done
L_ps_slow:
  s_mov_b32 s56, s39
  buffer_store_dwordx4 v[80:83], v6, s[20:23], s56 offen offset:0 sc1
  buffer_store_dwordx4 v[84:87], v6, s[20:23], s56 offen offset:512 sc1
  s_add_u32 s56, s56, 8192
  buffer_store_dwordx4 v[88:91], v6, s[20:23], s56 offen offset:0 sc1
  buffer_store_dwordx4 v[92:95], v6, s[20:23], s56 offen offset:512 sc1
  s_add_u32 s56, s56, 8192
  buffer_store_dwordx4 v[96:99], v6, s[20:23], s56 offen offset:0 sc1
  buffer_store_dwordx4 v[100:103], v6, s[20:23], s56 offen offset:512 sc1
  s_add_u32 s56, s56, 8192
  buffer_store_dwordx4 v[104:107], v6, s[20:23], s56 offen offset:0 sc1
  buffer_store_dwordx4 v[108:111], v6, s[20:23], s56 offen offset:512 sc1
  s_cmp_lg_u32 s38, 0
  s_cbranch_scc1 L_k_noz2
  s_lshl_b32 s5, s36, 4
  s_add_u32 s5, s5, s37
  s_lshl_b32 s56, s5, 8
  s_add_u32 s56, s56, 8388608
  buffer_store_dword v152, v12, s[24:27], s56 offen sc1
L_k_noz2:
L_ps_done:
  v_lshlrev_b32 v8, 2, v1
  v_lshrrev_b32 v10, 5, v1
  v_lshlrev_b32 v10, 19, v10
  v_and_b32 v7, 31, v1
  s_lshl_b32 s4, s38, 5
  v_add_u32 v7, s4, v7
  v_lshlrev_b32 v7, 4, v7
  v_add_u32 v10, v10, v7
  v_lshrrev_b32 v11, 5, v1
  v_lshlrev_b32 v11, 3, v11
  v_add_u32 v11, v11, v7
  s_lshl_b32 s57, s37, 2
  s_add_u32 s57, s57, s38
  s_lshl_b32 s57, s57, 2
  v_mov_b32 v6, s57
  v_mov_b32 v13, 1
  s_waitcnt vmcnt(0)
  s_mov_b64 exec, 1
  s_cmp_eq_u32 s94, 0
  s_cbranch_scc1 L_f1_slow
  buffer_store_dword v13, v6, s[24:27], s98 offen
  s_branch L_f1_done
L_f1_slow:
  buffer_store_dword v13, v6, s[24:27], s98 offen sc1
L_f1_done:
  s_mov_b64 exec, -1
L_k_nof1:
  s_lshl_b32 s56, s36, 20
  s_lshl_b32 s57, s37, 11
  s_add_u32 s56, s56, s57
  s_lshl_b32 s5, s36, 12
  s_add_u32 s5, s5, 8388608
  s_mov_b32 s63, 0
L_k_p1:
  buffer_load_dword v9, v8, s[24:27], s98 offen sc1
  s_waitcnt vmcnt(0)
  v_cmp_ne_u32 vcc, 0, v9
  s_cmp_eq_u64 vcc, -1
  s_cbranch_scc1 L_k_p1_done
  s_add_u32 s63, s63, 1
  s_cmp_lt_u32 s63, 262144
  s_cbranch_scc1 L_k_p1
  s_branch L_end
L_k_p1_done:
  s_cmp_lg_u32 s38, 3
  s_cbranch_scc1 L_k_nozl
  buffer_load_dword v48, v12, s[24:27], s5 offen offset:0 sc1
  buffer_load_dword v49, v12, s[24:27], s5 offen offset:256 sc1
  buffer_load_dword v50, v12, s[24:27], s5 offen offset:512 sc1
  buffer_load_dword v51, v12, s[24:27], s5 offen offset:768 sc1
  buffer_load_dword v52, v12, s[24:27], s5 offen offset:1024 sc1
  buffer_load_dword v53, v12, s[24:27], s5 offen offset:1280 sc1
  buffer_load_dword v54, v12, s[24:27], s5 offen offset:1536 sc1
  buffer_load_dword v55, v12, s[24:27], s5 offen offset:1792 sc1
  buffer_load_dword v56, v12, s[24:27], s5 offen offset:2048 sc1
  buffer_load_dword v57, v12, s[24:27], s5 offen offset:2304 sc1
  buffer_load_dword v58, v12, s[24:27], s5 offen offset:2560 sc1
  buffer_load_dword v59, v12, s[24:27], s5 offen offset:2816 sc1
  buffer_load_dword v60, v12, s[24:27], s5 offen offset:3072 sc1
  buffer_load_dword v61, v12, s[24:27], s5 offen offset:3328 sc1
  buffer_load_dword v62, v12, s[24:27], s5 offen offset:3584 sc1
  buffer_load_dword v63, v12, s[24:27], s5 offen offset:3840 sc1
  buffer_load_dwordx4 v[16:19], v10, s[20:23], s56 offen sc1
  s_add_u32 s56, s56, 65536
  buffer_load_dwordx4 v[20:23], v10, s[20:23], s56 offen sc1
  s_add_u32 s56, s56, 65536
  buffer_load_dwordx4 v[24:27], v10, s[20:23], s56 offen sc1
  s_add_u32 s56, s56, 65536
  buffer_load_dwordx4 v[28:31], v10, s[20:23], s56 offen sc1
  s_add_u32 s56, s56, 65536
  buffer_load_dwordx4 v[32:35], v10, s[20:23], s56 offen sc1
  s_add_u32 s56, s56, 65536
  buffer_load_dwordx4 v[36:39], v10, s[20:23], s56 offen sc1
  s_add_u32 s56, s56, 65536
  buffer_load_dwordx4 v[40:43], v10, s[20:23], s56 offen sc1
  s_add_u32 s56, s56, 65536
  buffer_load_dwordx4 v[44:47], v10, s[20:23], s56 offen sc1
  v_lshrrev_b32 v8, 4, v1
  v_lshlrev_b32 v8, 5, v8
  v_bfe_u32 v9, v1, 2, 1
  v_lshlrev_b32 v9, 4, v9
  v_add_u32 v8, v8, v9
  v_bfe_u32 v9, v1, 3, 1
  v_lshlrev_b32 v9, 3, v9
  v_add_u32 v8, v8, v9
  v_and_b32 v9, 3, v1
  v_lshlrev_b32 v9, 1, v9
  v_add_u32 v8, v8, v9
  s_waitcnt vmcnt(8)
  v_add_f32 v48, v48, v56
  v_add_f32 v49, v49, v57
  v_add_f32 v50, v50, v58
  v_add_f32 v51, v51, v59
  v_add_f32 v52, v52, v60
  v_add_f32 v53, v53, v61
  v_add_f32 v54, v54, v62
  v_add_f32 v55, v55, v63
  v_add_f32 v48, v48, v52
  v_add_f32 v49, v49, v53
  v_add_f32 v50, v50, v54
  v_add_f32 v51, v51, v55
  v_add_f32 v48, v48, v50
  v_add_f32 v49, v49, v51
  v_add_f32 v48, v48, v49
  v_cvt_pk_bf16_f32 v48, v48, v48
  ds_write_b16 v8, v48 offset:0
  v_mov_b32 v9, 800
  s_waitcnt lgkmcnt(0)
  ds_write_b32 v9, v13
  s_branch L_k_zdone
L_k_nozl:
  buffer_load_dwordx4 v[16:19], v10, s[20:23], s56 offen sc1
  s_add_u32 s56, s56, 65536
  buffer_load_dwordx4 v[20:23], v10, s[20:23], s56 offen sc1
  s_add_u32 s56, s56, 65536
  buffer_load_dwordx4 v[24:27], v10, s[20:23], s56 offen sc1
  s_add_u32 s56, s56, 65536
  buffer_load_dwordx4 v[28:31], v10, s[20:23], s56 offen sc1
  s_add_u32 s56, s56, 65536
  buffer_load_dwordx4 v[32:35], v10, s[20:23], s56 offen sc1
  s_add_u32 s56, s56, 65536
  buffer_load_dwordx4 v[36:39], v10, s[20:23], s56 offen sc1
  s_add_u32 s56, s56, 65536
  buffer_load_dwordx4 v[40:43], v10, s[20:23], s56 offen sc1
  s_add_u32 s56, s56, 65536
  buffer_load_dwordx4 v[44:47], v10, s[20:23], s56 offen sc1
L_k_zdone:
  s_waitcnt vmcnt(7)
  v_lshlrev_b32 v80, 16, v16
  v_and_b32 v81, 0xffff0000, v16
  v_lshlrev_b32 v82, 16, v17
  v_and_b32 v83, 0xffff0000, v17
  v_lshlrev_b32 v84, 16, v18
  v_and_b32 v85, 0xffff0000, v18
  v_lshlrev_b32 v86, 16, v19
  v_and_b32 v87, 0xffff0000, v19
  s_waitcnt vmcnt(6)
  v_lshlrev_b32 v88, 16, v20
  v_and_b32 v89, 0xffff0000, v20
  v_lshlrev_b32 v90, 16, v21
  v_and_b32 v91, 0xffff0000, v21
  v_lshlrev_b32 v92, 16, v22
  v_and_b32 v93, 0xffff0000, v22
  v_lshlrev_b32 v94, 16, v23
  v_and_b32 v95, 0xffff0000, v23
  v_pk_add_f32 v[80:81], v[80:81], v[88:89]
  v_pk_add_f32 v[82:83], v[82:83], v[90:91]
  v_pk_add_f32 v[84:85], v[84:85], v[92:93]
  v_pk_add_f32 v[86:87], v[86:87], v[94:95]
  s_waitcnt vmcnt(5)
  v_lshlrev_b32 v88, 16, v24
  v_and_b32 v89, 0xffff0000, v24
  v_lshlrev_b32 v90, 16, v25
  v_and_b32 v91, 0xffff0000, v25
  v_lshlrev_b32 v92, 16, v26
  v_and_b32 v93, 0xffff0000, v26
  v_lshlrev_b32 v94, 16, v27
  v_and_b32 v95, 0xffff0000, v27
  v_pk_add_f32 v[80:81], v[80:81], v[88:89]
  v_pk_add_f32 v[82:83], v[82:83], v[90:91]
  v_pk_add_f32 v[84:85], v[84:85], v[92:93]
  v_pk_add_f32 v[86:87], v[86:87], v[94:95]
  s_waitcnt vmcnt(4)
  v_lshlrev_b32 v88, 16, v28
  v_and_b32 v89, 0xffff0000, v28
  v_lshlrev_b32 v90, 16, v29
  v_and_b32 v91, 0xffff0000, v29
  v_lshlrev_b32 v92, 16, v30
  v_and_b32 v93, 0xffff0000, v30
  v_lshlrev_b32 v94, 16, v31
  v_and_b32 v95, 0xffff0000, v31
  v_pk_add_f32 v[80:81], v[80:81], v[88:89]
  v_pk_add_f32 v[82:83], v[82:83], v[90:91]
  v_pk_add_f32 v[84:85], v[84:85], v[92:93]
  v_pk_add_f32 v[86:87], v[86:87], v[94:95]
  s_waitcnt vmcnt(3)
  v_lshlrev_b32 v88, 16, v32
  v_and_b32 v89, 0xffff0000, v32
  v_lshlrev_b32 v90, 16, v33
  v_and_b32 v91, 0xffff0000, v33
  v_lshlrev_b32 v92, 16, v34
  v_and_b32 v93, 0xffff0000, v34
  v_lshlrev_b32 v94, 16, v35
  v_and_b32 v95, 0xffff0000, v35
  v_pk_add_f32 v[80:81], v[80:81], v[88:89]
  v_pk_add_f32 v[82:83], v[82:83], v[90:91]
  v_pk_add_f32 v[84:85], v[84:85], v[92:93]
  v_pk_add_f32 v[86:87], v[86:87], v[94:95]
  s_waitcnt vmcnt(2)
  v_lshlrev_b32 v88, 16, v36
  v_and_b32 v89, 0xffff0000, v36
  v_lshlrev_b32 v90, 16, v37
  v_and_b32 v91, 0xffff0000, v37
  v_lshlrev_b32 v92, 16, v38
  v_and_b32 v93, 0xffff0000, v38
  v_lshlrev_b32 v94, 16, v39
  v_and_b32 v95, 0xffff0000, v39
  v_pk_add_f32 v[80:81], v[80:81], v[88:89]
  v_pk_add_f32 v[82:83], v[82:83], v[90:91]
  v_pk_add_f32 v[84:85], v[84:85], v[92:93]
  v_pk_add_f32 v[86:87], v[86:87], v[94:95]
  s_waitcnt vmcnt(1)
  v_lshlrev_b32 v88, 16, v40
  v_and_b32 v89, 0xffff0000, v40
  v_lshlrev_b32 v90, 16, v41
  v_and_b32 v91, 0xffff0000, v41
  v_lshlrev_b32 v92, 16, v42
  v_and_b32 v93, 0xffff0000, v42
  v_lshlrev_b32 v94, 16, v43
  v_and_b32 v95, 0xffff0000, v43
  v_pk_add_f32 v[80:81], v[80:81], v[88:89]
  v_pk_add_f32 v[82:83], v[82:83], v[90:91]
  v_pk_add_f32 v[84:85], v[84:85], v[92:93]
  v_pk_add_f32 v[86:87], v[86:87], v[94:95]
  s_waitcnt vmcnt(0)
  v_lshlrev_b32 v88, 16, v44
  v_and_b32 v89, 0xffff0000, v44
  v_lshlrev_b32 v90, 16, v45
  v_and_b32 v91, 0xffff0000, v45
  v_lshlrev_b32 v92, 16, v46
  v_and_b32 v93, 0xffff0000, v46
  v_lshlrev_b32 v94, 16, v47
  v_and_b32 v95, 0xffff0000, v47
  v_pk_add_f32 v[80:81], v[80:81], v[88:89]
  v_pk_add_f32 v[82:83], v[82:83], v[90:91]
  v_pk_add_f32 v[84:85], v[84:85], v[92:93]
  v_pk_add_f32 v[86:87], v[86:87], v[94:95]
  s_nop 1
  v_permlane32_swap_b32 v80, v84
  v_permlane32_swap_b32 v81, v85
  v_permlane32_swap_b32 v82, v86
  v_permlane32_swap_b32 v83, v87
  s_lshl_b32 s56, s36, 15
  s_lshl_b32 s57, s37, 11
  v_add_f32 v80, v80, v84
  v_add_f32 v81, v81, v85
  v_add_f32 v82, v82, v86
  v_add_f32 v83, v83, v87
  s_add_u32 s56, s56, s57
  s_add_u32 s56, s56, 9437184
  v_cvt_pk_bf16_f32 v88, v80, v81
  v_cvt_pk_bf16_f32 v89, v82, v83
  s_cmp_eq_u32 s94, 0
  s_cbranch_scc1 L_s2_slow
  buffer_store_dwordx2 v[88:89], v11, s[24:27], s56 offen
  s_branch L_s2_done
L_s2_slow:
  buffer_store_dwordx2 v[88:89], v11, s[24:27], s56 offen sc1
L_s2_done:
  s_waitcnt vmcnt(0) lgkmcnt(0)
  s_mov_b64 exec, 1
  s_cmp_eq_u32 s94, 0
  s_cbranch_scc1 L_f2_slow
  buffer_store_dword v13, v6, s[24:27], s99 offen
  s_branch L_f2_done
L_f2_slow:
  buffer_store_dword v13, v6, s[24:27], s99 offen sc1
L_f2_done:
  s_mov_b64 exec, -1
L_k_nof2:
  s_endpgm
L_qteam:
  s_sub_u32 s38, s38, 4
  v_mov_b32 v7, 0
  v_lshrrev_b32 v6, 2, v1
  v_lshlrev_b32 v6, 16, v6
  v_and_b32 v8, 3, v1
  v_lshlrev_b32 v8, 2, v8
  v_add_u32 v6, v6, v8
  s_lshl_b32 s5, s37, 4
  s_add_u32 s5, s5, s98
  s_cmp_lg_u32 s38, 0
  s_cbranch_scc1 L_q_noclr
  s_waitcnt lgkmcnt(0)
  s_mov_b32 s24, s52
  s_mov_b32 s25, s53
  s_mov_b64 exec, 255
  buffer_store_dword v7, v6, s[24:27], s5 offen sc1
  s_mov_b64 exec, 0xffff
  v_lshlrev_b32 v6, 2, v1
  ds_write_b32 v6, v7 offset:768
  s_mov_b64 exec, -1
  s_mov_b32 s32, s50
  s_mov_b32 s33, s51
  s_mov_b32 s34, 256
  s_mov_b32 s35, 0x20000
  s_getreg_b32 s95, hwreg(HW_REG_XCC_ID, 0, 4)
  s_lshl_b32 s4, s36, 4
  v_mov_b32 v6, s4
  s_lshl_b32 s5, s95, 3
  s_mov_b64 s[96:97], 1
  s_lshl_b64 s[96:97], s[96:97], s5
  v_mov_b32 v8, s96
  v_mov_b32 v9, s97
  s_waitcnt vmcnt(0)
  s_mov_b64 exec, 1
  buffer_atomic_add_x2 v[8:9], v6, s[32:35], 0 offen sc1
  s_mov_b64 exec, -1
L_q_noclr:
  s_waitcnt lgkmcnt(0)
  s_mov_b32 s24, s52
  s_mov_b32 s25, s53
  s_add_u32 s0, s52, s98
  s_addc_u32 s1, s53, 0
  s_mov_b32 s8, s40
  s_mov_b32 s9, s41
  s_mov_b32 s10, 16777216
  s_mov_b32 s11, 0x20000
  s_mov_b32 s20, s48
  s_mov_b32 s21, s49
  s_mov_b32 s22, 16777216
  s_mov_b32 s23, 0x20000
  s_mov_b32 s16, s44
  s_mov_b32 s17, s45
  s_mov_b32 s18, 16777216
  s_mov_b32 s19, 0x20000
  s_mov_b32 s32, s50
  s_mov_b32 s33, s51
  s_mov_b32 s34, 256
  s_mov_b32 s35, 0x20000
  s_mov_b32 s61, 0x3e800000
  s_mov_b32 s62, 0x3fb8aa3b
  v_and_b32 v3, 31, v1
  v_lshlrev_b32 v3, 9, v3
  v_lshrrev_b32 v4, 5, v1
  v_lshlrev_b32 v4, 4, v4
  v_add_u32 v3, v3, v4
  v_lshlrev_b32 v5, 4, v1
  v_mov_b32 v184, 0
  v_mov_b32 v185, 0
  v_mov_b32 v186, 0
  v_mov_b32 v187, 0
  v_mov_b32 v188, 0xc0400000
  s_lshl_b32 s4, s38, 14
  s_add_u32 s58, s39, s4
  v_and_b32 v6, 31, v1
  v_lshlrev_b32 v112, 9, v6
  v_and_b32 v6, 15, v1
  v_lshrrev_b32 v7, 5, v1
  v_xor_b32 v6, v6, v7
  v_lshlrev_b32 v6, 4, v6
  v_add_u32 v112, v112, v6
  v_add_u32 v112, 2048, v112
  v_xor_b32 v113, 32, v112
  v_xor_b32 v114, 64, v112
  v_xor_b32 v115, 96, v112
  v_xor_b32 v116, 128, v112
  v_xor_b32 v117, 160, v112
  v_xor_b32 v118, 192, v112
  v_xor_b32 v119, 224, v112
  v_lshrrev_b32 v4, 3, v1
  v_lshlrev_b32 v4, 9, v4
  v_lshrrev_b32 v8, 4, v1
  v_and_b32 v8, 1, v8
  v_lshlrev_b32 v8, 2, v8
  v_and_b32 v6, 7, v1
  v_xor_b32 v8, v8, v6
  v_lshlrev_b32 v8, 4, v8
  v_add_u32 v4, v4, v8
  s_lshl_b32 s4, s38, 7
  s_add_u32 s59, s39, s4
  s_lshl_b32 s4, s38, 14
  s_add_u32 s60, s4, 83968
  s_lshl_b32 s4, s38, 2
  s_add_u32 s4, s4, 784
  v_mov_b32 v12, s4
  v_mov_b32 v14, 0
  s_barrier
  s_mov_b32 m0, s60
  s_add_u32 s60, s60, 1024
  buffer_load_dwordx4 v4, s[16:19], s59 offen nt lds
  s_add_u32 s59, s59, 4096
  s_mov_b32 m0, s60
  s_add_u32 s60, s60, 1024
  buffer_load_dwordx4 v4, s[16:19], s59 offen nt lds
  s_add_u32 s59, s59, 4096
  s_mov_b32 m0, s60
  s_add_u32 s60, s60, 1024
  buffer_load_dwordx4 v4, s[16:19], s59 offen nt lds
  s_add_u32 s59, s59, 4096
  s_mov_b32 m0, s60
  s_add_u32 s60, s60, 1024
  buffer_load_dwordx4 v4, s[16:19], s59 offen nt lds
  s_add_u32 s59, s59, 4096
  s_mov_b32 m0, s60
  s_add_u32 s60, s60, 1024
  buffer_load_dwordx4 v4, s[16:19], s59 offen nt lds
  s_add_u32 s59, s59, 4096
  s_mov_b32 m0, s60
  s_add_u32 s60, s60, 1024
  buffer_load_dwordx4 v4, s[16:19], s59 offen nt lds
  s_add_u32 s59, s59, 4096
  s_mov_b32 m0, s60
  s_add_u32 s60, s60, 1024
  buffer_load_dwordx4 v4, s[16:19], s59 offen nt lds
  s_add_u32 s59, s59, 4096
  s_mov_b32 m0, s60
  s_add_u32 s60, s60, 1024
  buffer_load_dwordx4 v4, s[16:19], s59 offen nt lds
  s_add_u32 s59, s59, 4096
  s_mov_b32 m0, s60
  s_add_u32 s60, s60, 1024
  buffer_load_dwordx4 v4, s[16:19], s59 offen nt lds
  s_add_u32 s59, s59, 4096
  s_mov_b32 m0, s60
  s_add_u32 s60, s60, 1024
  buffer_load_dwordx4 v4, s[16:19], s59 offen nt lds
  s_add_u32 s59, s59, 4096
  s_mov_b32 m0, s60
  s_add_u32 s60, s60, 1024
  buffer_load_dwordx4 v4, s[16:19], s59 offen nt lds
  s_add_u32 s59, s59, 4096
  s_mov_b32 m0, s60
  s_add_u32 s60, s60, 1024
  buffer_load_dwordx4 v4, s[16:19], s59 offen nt lds
  s_add_u32 s59, s59, 4096
  s_mov_b32 m0, s60
  s_add_u32 s60, s60, 1024
  buffer_load_dwordx4 v4, s[16:19], s59 offen nt lds
  s_add_u32 s59, s59, 4096
  s_mov_b32 m0, s60
  s_add_u32 s60, s60, 1024
  buffer_load_dwordx4 v4, s[16:19], s59 offen nt lds
  s_add_u32 s59, s59, 4096
  s_mov_b32 m0, s60
  s_add_u32 s60, s60, 1024
  buffer_load_dwordx4 v4, s[16:19], s59 offen nt lds
  s_add_u32 s59, s59, 4096
  s_mov_b32 m0, s60
  s_add_u32 s60, s60, 1024
  buffer_load_dwordx4 v4, s[16:19], s59 offen nt lds
  s_add_u32 s59, s59, 4096
  s_cmp_lg_u32 s38, 0
  s_cbranch_scc1 L_q_nord
  s_lshl_b32 s4, s36, 4
  buffer_load_dwordx2 v[10:11], v14, s[32:35], s4 offen sc1
L_q_nord:
  buffer_load_dwordx4 v[16:19], v3, s[8:11], s58 offen offset:0
  buffer_load_dwordx4 v[20:23], v3, s[8:11], s58 offen offset:32
  buffer_load_dwordx4 v[24:27], v3, s[8:11], s58 offen offset:64
  buffer_load_dwordx4 v[28:31], v3, s[8:11], s58 offen offset:96
  s_waitcnt vmcnt(12)
  v_mov_b32 v13, 1
  ds_write_b32 v12, v13
  buffer_load_dwordx4 v[32:35], v3, s[8:11], s58 offen offset:128
  buffer_load_dwordx4 v[36:39], v3, s[8:11], s58 offen offset:160
  buffer_load_dwordx4 v[40:43], v3, s[8:11], s58 offen offset:192
  buffer_load_dwordx4 v[44:47], v3, s[8:11], s58 offen offset:224
  buffer_load_dwordx4 v[48:51], v3, s[8:11], s58 offen offset:256
  buffer_load_dwordx4 v[52:55], v3, s[8:11], s58 offen offset:288
  buffer_load_dwordx4 v[56:59], v3, s[8:11], s58 offen offset:320
  buffer_load_dwordx4 v[60:63], v3, s[8:11], s58 offen offset:352
  s_waitcnt vmcnt(12)
  s_cmp_lg_u32 s38, 0
  s_cbranch_scc1 L_q_nordw
  v_mov_b32 v13, 640
  ds_write_b64 v13, v[10:11]
  s_waitcnt lgkmcnt(0)
L_q_nordw:
  v_mov_b32 v13, 2
  ds_write_b32 v12, v13
  buffer_load_dwordx4 v[64:67], v3, s[8:11], s58 offen offset:384
  buffer_load_dwordx4 v[68:71], v3, s[8:11], s58 offen offset:416
  buffer_load_dwordx4 v[72:75], v3, s[8:11], s58 offen offset:448
  buffer_load_dwordx4 v[76:79], v3, s[8:11], s58 offen offset:480
  ds_read_b128 a[0:3], v112 offset:0
  ds_read_b128 a[4:7], v112 offset:16384
  ds_read_b128 a[8:11], v113 offset:0
  ds_read_b128 a[12:15], v113 offset:16384
  s_waitcnt vmcnt(15) lgkmcnt(2)
  v_mfma_f32_32x32x16_bf16 v[80:95], a[0:3], v[16:19], 0
  v_mfma_f32_32x32x16_bf16 v[96:111], a[4:7], v[16:19], 0
  v_dot2c_f32_bf16 v184, v16, v16
  v_dot2c_f32_bf16 v185, v17, v17
  v_dot2c_f32_bf16 v186, v18, v18
  v_dot2c_f32_bf16 v187, v19, v19
  ds_read_b128 a[0:3], v114 offset:0
  ds_read_b128 a[4:7], v114 offset:16384
  s_waitcnt vmcnt(14) lgkmcnt(2)
  v_mfma_f32_32x32x16_bf16 v[80:95], a[8:11], v[20:23], v[80:95]
  v_mfma_f32_32x32x16_bf16 v[96:111], a[12:15], v[20:23], v[96:111]
  v_dot2c_f32_bf16 v184, v20, v20
  v_dot2c_f32_bf16 v185, v21, v21
  v_dot2c_f32_bf16 v186, v22, v22
  v_dot2c_f32_bf16 v187, v23, v23
  ds_read_b128 a[8:11], v115 offset:0
  ds_read_b128 a[12:15], v115 offset:16384
  s_waitcnt vmcnt(13) lgkmcnt(2)
  v_mfma_f32_32x32x16_bf16 v[80:95], a[0:3], v[24:27], v[80:95]
  v_mfma_f32_32x32x16_bf16 v[96:111], a[4:7], v[24:27], v[96:111]
  v_dot2c_f32_bf16 v184, v24, v24
  v_dot2c_f32_bf16 v185, v25, v25
  v_dot2c_f32_bf16 v186, v26, v26
  v_dot2c_f32_bf16 v187, v27, v27
  ds_read_b128 a[0:3], v116 offset:0
  ds_read_b128 a[4:7], v116 offset:16384
  s_waitcnt vmcnt(12) lgkmcnt(2)
  v_mfma_f32_32x32x16_bf16 v[80:95], a[8:11], v[28:31], v[80:95]
  v_mfma_f32_32x32x16_bf16 v[96:111], a[12:15], v[28:31], v[96:111]
  v_dot2c_f32_bf16 v184, v28, v28
  v_dot2c_f32_bf16 v185, v29, v29
  v_dot2c_f32_bf16 v186, v30, v30
  v_dot2c_f32_bf16 v187, v31, v31
  ds_read_b128 a[8:11], v117 offset:0
  ds_read_b128 a[12:15], v117 offset:16384
  s_waitcnt vmcnt(11) lgkmcnt(2)
  v_mfma_f32_32x32x16_bf16 v[80:95], a[0:3], v[32:35], v[80:95]
  v_mfma_f32_32x32x16_bf16 v[96:111], a[4:7], v[32:35], v[96:111]
  v_dot2c_f32_bf16 v184, v32, v32
  v_dot2c_f32_bf16 v185, v33, v33
  v_dot2c_f32_bf16 v186, v34, v34
  v_dot2c_f32_bf16 v187, v35, v35
  ds_read_b128 a[0:3], v118 offset:0
  ds_read_b128 a[4:7], v118 offset:16384
  s_waitcnt vmcnt(10) lgkmcnt(2)
  v_mfma_f32_32x32x16_bf16 v[80:95], a[8:11], v[36:39], v[80:95]
  v_mfma_f32_32x32x16_bf16 v[96:111], a[12:15], v[36:39], v[96:111]
  v_dot2c_f32_bf16 v184, v36, v36
  v_dot2c_f32_bf16 v185, v37, v37
  v_dot2c_f32_bf16 v186, v38, v38
  v_dot2c_f32_bf16 v187, v39, v39
  ds_read_b128 a[8:11], v119 offset:0
  ds_read_b128 a[12:15], v119 offset:16384
  s_waitcnt vmcnt(9) lgkmcnt(2)
  v_mfma_f32_32x32x16_bf16 v[80:95], a[0:3], v[40:43], v[80:95]
  v_mfma_f32_32x32x16_bf16 v[96:111], a[4:7], v[40:43], v[96:111]
  v_dot2c_f32_bf16 v184, v40, v40
  v_dot2c_f32_bf16 v185, v41, v41
  v_dot2c_f32_bf16 v186, v42, v42
  v_dot2c_f32_bf16 v187, v43, v43
  ds_read_b128 a[0:3], v112 offset:256
  ds_read_b128 a[4:7], v112 offset:16640
  s_waitcnt vmcnt(8) lgkmcnt(2)
  v_mfma_f32_32x32x16_bf16 v[80:95], a[8:11], v[44:47], v[80:95]
  v_mfma_f32_32x32x16_bf16 v[96:111], a[12:15], v[44:47], v[96:111]
  v_dot2c_f32_bf16 v184, v44, v44
  v_dot2c_f32_bf16 v185, v45, v45
  v_dot2c_f32_bf16 v186, v46, v46
  v_dot2c_f32_bf16 v187, v47, v47
  ds_read_b128 a[8:11], v113 offset:256
  ds_read_b128 a[12:15], v113 offset:16640
  s_waitcnt vmcnt(7) lgkmcnt(2)
  v_mfma_f32_32x32x16_bf16 v[80:95], a[0:3], v[48:51], v[80:95]
  v_mfma_f32_32x32x16_bf16 v[96:111], a[4:7], v[48:51], v[96:111]
  v_dot2c_f32_bf16 v184, v48, v48
  v_dot2c_f32_bf16 v185, v49, v49
  v_dot2c_f32_bf16 v186, v50, v50
  v_dot2c_f32_bf16 v187, v51, v51
  ds_read_b128 a[0:3], v114 offset:256
  ds_read_b128 a[4:7], v114 offset:16640
  s_waitcnt vmcnt(6) lgkmcnt(2)
  v_mfma_f32_32x32x16_bf16 v[80:95], a[8:11], v[52:55], v[80:95]
  v_mfma_f32_32x32x16_bf16 v[96:111], a[12:15], v[52:55], v[96:111]
  v_dot2c_f32_bf16 v184, v52, v52
  v_dot2c_f32_bf16 v185, v53, v53
  v_dot2c_f32_bf16 v186, v54, v54
  v_dot2c_f32_bf16 v187, v55, v55
  ds_read_b128 a[8:11], v115 offset:256
  ds_read_b128 a[12:15], v115 offset:16640
  s_waitcnt vmcnt(5) lgkmcnt(2)
  v_mfma_f32_32x32x16_bf16 v[80:95], a[0:3], v[56:59], v[80:95]
  v_mfma_f32_32x32x16_bf16 v[96:111], a[4:7], v[56:59], v[96:111]
  v_dot2c_f32_bf16 v184, v56, v56
  v_dot2c_f32_bf16 v185, v57, v57
  v_dot2c_f32_bf16 v186, v58, v58
  v_dot2c_f32_bf16 v187, v59, v59
  ds_read_b128 a[0:3], v116 offset:256
  ds_read_b128 a[4:7], v116 offset:16640
  s_waitcnt vmcnt(4) lgkmcnt(2)
  v_mfma_f32_32x32x16_bf16 v[80:95], a[8:11], v[60:63], v[80:95]
  v_mfma_f32_32x32x16_bf16 v[96:111], a[12:15], v[60:63], v[96:111]
  v_dot2c_f32_bf16 v184, v60, v60
  v_dot2c_f32_bf16 v185, v61, v61
  v_dot2c_f32_bf16 v186, v62, v62
  v_dot2c_f32_bf16 v187, v63, v63
  ds_read_b128 a[8:11], v117 offset:256
  ds_read_b128 a[12:15], v117 offset:16640
  s_waitcnt vmcnt(3) lgkmcnt(2)
  v_mfma_f32_32x32x16_bf16 v[80:95], a[0:3], v[64:67], v[80:95]
  v_mfma_f32_32x32x16_bf16 v[96:111], a[4:7], v[64:67], v[96:111]
  v_dot2c_f32_bf16 v184, v64, v64
  v_dot2c_f32_bf16 v185, v65, v65
  v_dot2c_f32_bf16 v186, v66, v66
  v_dot2c_f32_bf16 v187, v67, v67
  ds_read_b128 a[0:3], v118 offset:256
  ds_read_b128 a[4:7], v118 offset:16640
  s_waitcnt vmcnt(2) lgkmcnt(2)
  v_mfma_f32_32x32x16_bf16 v[80:95], a[8:11], v[68:71], v[80:95]
  v_mfma_f32_32x32x16_bf16 v[96:111], a[12:15], v[68:71], v[96:111]
  v_dot2c_f32_bf16 v184, v68, v68
  v_dot2c_f32_bf16 v185, v69, v69
  v_dot2c_f32_bf16 v186, v70, v70
  v_dot2c_f32_bf16 v187, v71, v71
  ds_read_b128 a[8:11], v119 offset:256
  ds_read_b128 a[12:15], v119 offset:16640
  s_waitcnt vmcnt(1) lgkmcnt(2)
  v_mfma_f32_32x32x16_bf16 v[80:95], a[0:3], v[72:75], v[80:95]
  v_mfma_f32_32x32x16_bf16 v[96:111], a[4:7], v[72:75], v[96:111]
  v_dot2c_f32_bf16 v184, v72, v72
  v_dot2c_f32_bf16 v185, v73, v73
  v_dot2c_f32_bf16 v186, v74, v74
  v_dot2c_f32_bf16 v187, v75, v75
  s_waitcnt vmcnt(0) lgkmcnt(0)
  v_mfma_f32_32x32x16_bf16 v[80:95], a[8:11], v[76:79], v[80:95]
  v_mfma_f32_32x32x16_bf16 v[96:111], a[12:15], v[76:79], v[96:111]
  v_dot2c_f32_bf16 v184, v76, v76
  v_dot2c_f32_bf16 v185, v77, v77
  v_dot2c_f32_bf16 v186, v78, v78
  v_dot2c_f32_bf16 v187, v79, v79
  s_nop 3
  v_add_f32 v184, v184, v185
  v_add_f32 v186, v186, v187
  v_add_f32 v184, v184, v186
  v_mov_b32 v176, v184
  s_nop 1
  v_permlane32_swap_b32 v176, v184
  s_nop 1
  v_add_f32 v184, v184, v176
  v_mul_f32 v184, 0x3d800000, v184
  v_cvt_pk_bf16_f32 v184, 0, v184
  v_mul_f32 v184, 0.5, v184
  s_nop 3
  v_cvt_pk_bf16_f32 v176, 0, v80
  v_cvt_pk_bf16_f32 v177, 0, v81
  v_cvt_pk_bf16_f32 v178, 0, v82
  v_cvt_pk_bf16_f32 v179, 0, v83
  v_cvt_pk_bf16_f32 v180, 0, v84
  v_cvt_pk_bf16_f32 v181, 0, v85
  v_cvt_pk_bf16_f32 v182, 0, v86
  v_cvt_pk_bf16_f32 v183, 0, v87
  v_fma_f32 v176, v176, s61, -v184
  v_fma_f32 v177, v177, s61, -v184
  v_fma_f32 v178, v178, s61, -v184
  v_fma_f32 v179, v179, s61, -v184
  v_fma_f32 v180, v180, s61, -v184
  v_fma_f32 v181, v181, s61, -v184
  v_fma_f32 v182, v182, s61, -v184
  v_fma_f32 v183, v183, s61, -v184
  v_cvt_pk_bf16_f32 v176, 0, v176
  v_cvt_pk_bf16_f32 v177, 0, v177
  v_cvt_pk_bf16_f32 v178, 0, v178
  v_cvt_pk_bf16_f32 v179, 0, v179
  v_cvt_pk_bf16_f32 v180, 0, v180
  v_cvt_pk_bf16_f32 v181, 0, v181
  v_cvt_pk_bf16_f32 v182, 0, v182
  v_cvt_pk_bf16_f32 v183, 0, v183
  v_fma_f32 v176, v176, s62, v188
  v_fma_f32 v177, v177, s62, v188
  v_fma_f32 v178, v178, s62, v188
  v_fma_f32 v179, v179, s62, v188
  v_fma_f32 v180, v180, s62, v188
  v_fma_f32 v181, v181, s62, v188
  v_fma_f32 v182, v182, s62, v188
  v_fma_f32 v183, v183, s62, v188
  v_exp_f32 v176, v176
  v_exp_f32 v177, v177
  v_exp_f32 v178, v178
  v_exp_f32 v179, v179
  v_exp_f32 v180, v180
  v_exp_f32 v181, v181
  v_exp_f32 v182, v182
  v_exp_f32 v183, v183
  s_nop 0
  v_add_f32 v176, 0x358637bd, v176
  v_add_f32 v177, 0x358637bd, v177
  v_add_f32 v178, 0x358637bd, v178
  v_add_f32 v179, 0x358637bd, v179
  v_add_f32 v180, 0x358637bd, v180
  v_add_f32 v181, 0x358637bd, v181
  v_add_f32 v182, 0x358637bd, v182
  v_add_f32 v183, 0x358637bd, v183
  v_cvt_pk_bf16_f32 v160, v176, v177
  v_cvt_pk_bf16_f32 v161, v178, v179
  v_cvt_pk_bf16_f32 v162, v180, v181
  v_cvt_pk_bf16_f32 v163, v182, v183
  v_cvt_pk_bf16_f32 v80, 0, v176
  v_cvt_pk_bf16_f32 v81, 0, v177
  v_cvt_pk_bf16_f32 v82, 0, v178
  v_cvt_pk_bf16_f32 v83, 0, v179
  v_cvt_pk_bf16_f32 v84, 0, v180
  v_cvt_pk_bf16_f32 v85, 0, v181
  v_cvt_pk_bf16_f32 v86, 0, v182
  v_cvt_pk_bf16_f32 v87, 0, v183
  v_cvt_pk_bf16_f32 v176, 0, v88
  v_cvt_pk_bf16_f32 v177, 0, v89
  v_cvt_pk_bf16_f32 v178, 0, v90
  v_cvt_pk_bf16_f32 v179, 0, v91
  v_cvt_pk_bf16_f32 v180, 0, v92
  v_cvt_pk_bf16_f32 v181, 0, v93
  v_cvt_pk_bf16_f32 v182, 0, v94
  v_cvt_pk_bf16_f32 v183, 0, v95
  v_fma_f32 v176, v176, s61, -v184
  v_fma_f32 v177, v177, s61, -v184
  v_fma_f32 v178, v178, s61, -v184
  v_fma_f32 v179, v179, s61, -v184
  v_fma_f32 v180, v180, s61, -v184
  v_fma_f32 v181, v181, s61, -v184
  v_fma_f32 v182, v182, s61, -v184
  v_fma_f32 v183, v183, s61, -v184
  v_cvt_pk_bf16_f32 v176, 0, v176
  v_cvt_pk_bf16_f32 v177, 0, v177
  v_cvt_pk_bf16_f32 v178, 0, v178
  v_cvt_pk_bf16_f32 v179, 0, v179
  v_cvt_pk_bf16_f32 v180, 0, v180
  v_cvt_pk_bf16_f32 v181, 0, v181
  v_cvt_pk_bf16_f32 v182, 0, v182
  v_cvt_pk_bf16_f32 v183, 0, v183
  v_fma_f32 v176, v176, s62, v188
  v_fma_f32 v177, v177, s62, v188
  v_fma_f32 v178, v178, s62, v188
  v_fma_f32 v179, v179, s62, v188
  v_fma_f32 v180, v180, s62, v188
  v_fma_f32 v181, v181, s62, v188
  v_fma_f32 v182, v182, s62, v188
  v_fma_f32 v183, v183, s62, v188
  v_exp_f32 v176, v176
  v_exp_f32 v177, v177
  v_exp_f32 v178, v178
  v_exp_f32 v179, v179
  v_exp_f32 v180, v180
  v_exp_f32 v181, v181
  v_exp_f32 v182, v182
  v_exp_f32 v183, v183
  s_nop 0
  v_add_f32 v176, 0x358637bd, v176
  v_add_f32 v177, 0x358637bd, v177
  v_add_f32 v178, 0x358637bd, v178
  v_add_f32 v179, 0x358637bd, v179
  v_add_f32 v180, 0x358637bd, v180
  v_add_f32 v181, 0x358637bd, v181
  v_add_f32 v182, 0x358637bd, v182
  v_add_f32 v183, 0x358637bd, v183
  v_cvt_pk_bf16_f32 v164, v176, v177
  v_cvt_pk_bf16_f32 v165, v178, v179
  v_cvt_pk_bf16_f32 v166, v180, v181
  v_cvt_pk_bf16_f32 v167, v182, v183
  v_cvt_pk_bf16_f32 v88, 0, v176
  v_cvt_pk_bf16_f32 v89, 0, v177
  v_cvt_pk_bf16_f32 v90, 0, v178
  v_cvt_pk_bf16_f32 v91, 0, v179
  v_cvt_pk_bf16_f32 v92, 0, v180
  v_cvt_pk_bf16_f32 v93, 0, v181
  v_cvt_pk_bf16_f32 v94, 0, v182
  v_cvt_pk_bf16_f32 v95, 0, v183
  v_cvt_pk_bf16_f32 v176, 0, v96
  v_cvt_pk_bf16_f32 v177, 0, v97
  v_cvt_pk_bf16_f32 v178, 0, v98
  v_cvt_pk_bf16_f32 v179, 0, v99
  v_cvt_pk_bf16_f32 v180, 0, v100
  v_cvt_pk_bf16_f32 v181, 0, v101
  v_cvt_pk_bf16_f32 v182, 0, v102
  v_cvt_pk_bf16_f32 v183, 0, v103
  v_fma_f32 v176, v176, s61, -v184
  v_fma_f32 v177, v177, s61, -v184
  v_fma_f32 v178, v178, s61, -v184
  v_fma_f32 v179, v179, s61, -v184
  v_fma_f32 v180, v180, s61, -v184
  v_fma_f32 v181, v181, s61, -v184
  v_fma_f32 v182, v182, s61, -v184
  v_fma_f32 v183, v183, s61, -v184
  v_cvt_pk_bf16_f32 v176, 0, v176
  v_cvt_pk_bf16_f32 v177, 0, v177
  v_cvt_pk_bf16_f32 v178, 0, v178
  v_cvt_pk_bf16_f32 v179, 0, v179
  v_cvt_pk_bf16_f32 v180, 0, v180
  v_cvt_pk_bf16_f32 v181, 0, v181
  v_cvt_pk_bf16_f32 v182, 0, v182
  v_cvt_pk_bf16_f32 v183, 0, v183
  v_fma_f32 v176, v176, s62, v188
  v_fma_f32 v177, v177, s62, v188
  v_fma_f32 v178, v178, s62, v188
  v_fma_f32 v179, v179, s62, v188
  v_fma_f32 v180, v180, s62, v188
  v_fma_f32 v181, v181, s62, v188
  v_fma_f32 v182, v182, s62, v188
  v_fma_f32 v183, v183, s62, v188
  v_exp_f32 v176, v176
  v_exp_f32 v177, v177
  v_exp_f32 v178, v178
  v_exp_f32 v179, v179
  v_exp_f32 v180, v180
  v_exp_f32 v181, v181
  v_exp_f32 v182, v182
  v_exp_f32 v183, v183
  s_nop 0
  v_add_f32 v176, 0x358637bd, v176
  v_add_f32 v177, 0x358637bd, v177
  v_add_f32 v178, 0x358637bd, v178
  v_add_f32 v179, 0x358637bd, v179
  v_add_f32 v180, 0x358637bd, v180
  v_add_f32 v181, 0x358637bd, v181
  v_add_f32 v182, 0x358637bd, v182
  v_add_f32 v183, 0x358637bd, v183
  v_cvt_pk_bf16_f32 v168, v176, v177
  v_cvt_pk_bf16_f32 v169, v178, v179
  v_cvt_pk_bf16_f32 v170, v180, v181
  v_cvt_pk_bf16_f32 v171, v182, v183
  v_cvt_pk_bf16_f32 v96, 0, v176
  v_cvt_pk_bf16_f32 v97, 0, v177
  v_cvt_pk_bf16_f32 v98, 0, v178
  v_cvt_pk_bf16_f32 v99, 0, v179
  v_cvt_pk_bf16_f32 v100, 0, v180
  v_cvt_pk_bf16_f32 v101, 0, v181
  v_cvt_pk_bf16_f32 v102, 0, v182
  v_cvt_pk_bf16_f32 v103, 0, v183
  v_cvt_pk_bf16_f32 v176, 0, v104
  v_cvt_pk_bf16_f32 v177, 0, v105
  v_cvt_pk_bf16_f32 v178, 0, v106
  v_cvt_pk_bf16_f32 v179, 0, v107
  v_cvt_pk_bf16_f32 v180, 0, v108
  v_cvt_pk_bf16_f32 v181, 0, v109
  v_cvt_pk_bf16_f32 v182, 0, v110
  v_cvt_pk_bf16_f32 v183, 0, v111
  v_fma_f32 v176, v176, s61, -v184
  v_fma_f32 v177, v177, s61, -v184
  v_fma_f32 v178, v178, s61, -v184
  v_fma_f32 v179, v179, s61, -v184
  v_fma_f32 v180, v180, s61, -v184
  v_fma_f32 v181, v181, s61, -v184
  v_fma_f32 v182, v182, s61, -v184
  v_fma_f32 v183, v183, s61, -v184
  v_cvt_pk_bf16_f32 v176, 0, v176
  v_cvt_pk_bf16_f32 v177, 0, v177
  v_cvt_pk_bf16_f32 v178, 0, v178
  v_cvt_pk_bf16_f32 v179, 0, v179
  v_cvt_pk_bf16_f32 v180, 0, v180
  v_cvt_pk_bf16_f32 v181, 0, v181
  v_cvt_pk_bf16_f32 v182, 0, v182
  v_cvt_pk_bf16_f32 v183, 0, v183
  v_fma_f32 v176, v176, s62, v188
  v_fma_f32 v177, v177, s62, v188
  v_fma_f32 v178, v178, s62, v188
  v_fma_f32 v179, v179, s62, v188
  v_fma_f32 v180, v180, s62, v188
  v_fma_f32 v181, v181, s62, v188
  v_fma_f32 v182, v182, s62, v188
  v_fma_f32 v183, v183, s62, v188
  v_exp_f32 v176, v176
  v_exp_f32 v177, v177
  v_exp_f32 v178, v178
  v_exp_f32 v179, v179
  v_exp_f32 v180, v180
  v_exp_f32 v181, v181
  v_exp_f32 v182, v182
  v_exp_f32 v183, v183
  s_nop 0
  v_add_f32 v176, 0x358637bd, v176
  v_add_f32 v177, 0x358637bd, v177
  v_add_f32 v178, 0x358637bd, v178
  v_add_f32 v179, 0x358637bd, v179
  v_add_f32 v180, 0x358637bd, v180
  v_add_f32 v181, 0x358637bd, v181
  v_add_f32 v182, 0x358637bd, v182
  v_add_f32 v183, 0x358637bd, v183
  v_cvt_pk_bf16_f32 v172, v176, v177
  v_cvt_pk_bf16_f32 v173, v178, v179
  v_cvt_pk_bf16_f32 v174, v180, v181
  v_cvt_pk_bf16_f32 v175, v182, v183
  v_cvt_pk_bf16_f32 v104, 0, v176
  v_cvt_pk_bf16_f32 v105, 0, v177
  v_cvt_pk_bf16_f32 v106, 0, v178
  v_cvt_pk_bf16_f32 v107, 0, v179
  v_cvt_pk_bf16_f32 v108, 0, v180
  v_cvt_pk_bf16_f32 v109, 0, v181
  v_cvt_pk_bf16_f32 v110, 0, v182
  v_cvt_pk_bf16_f32 v111, 0, v183
  v_lshlrev_b32 v8, 2, v1
  s_lshl_b32 s56, s36, 15
  s_lshl_b32 s5, s38, 13
  s_add_u32 s56, s56, s5
  s_add_u32 s56, s56, 9437184
  s_add_u32 s60, s5, 51200
  v_lshrrev_b32 v10, 5, v1
  v_lshlrev_b32 v6, 11, v10
  v_lshlrev_b32 v10, 4, v10
  v_and_b32 v7, 31, v1
  v_lshlrev_b32 v7, 3, v7
  v_add_u32 v6, v6, v7
  v_add_u32 v11, 51200, v5
  v_mov_b32 v14, 800
  s_mov_b32 s63, 0
L_q_z:
  ds_read_b32 v13, v14
  s_waitcnt lgkmcnt(0)
  v_readfirstlane_b32 s4, v13
  s_cmp_ge_u32 s4, 1
  s_cbranch_scc1 L_q_z_done
  s_sleep 1
  s_add_u32 s63, s63, 1
  s_cmp_lt_u32 s63, 2097152
  s_cbranch_scc1 L_q_z
  s_branch L_end
L_q_z_done:
  ds_read_b128 a[0:3], v10 offset:0
  ds_read_b128 a[4:7], v10 offset:32
  ds_read_b128 a[8:11], v10 offset:64
  ds_read_b128 a[12:15], v10 offset:96
  s_waitcnt lgkmcnt(3)
  v_mfma_f32_32x32x16_bf16 v[144:159], a[0:3], v[160:163], 0
  s_waitcnt lgkmcnt(2)
  v_mfma_f32_32x32x16_bf16 v[144:159], a[4:7], v[164:167], v[144:159]
  s_waitcnt lgkmcnt(1)
  v_mfma_f32_32x32x16_bf16 v[144:159], a[8:11], v[168:171], v[144:159]
  s_waitcnt lgkmcnt(0)
  v_mfma_f32_32x32x16_bf16 v[144:159], a[12:15], v[172:175], v[144:159]
  s_nop 15
  v_cvt_pk_bf16_f32 v144, 0, v144
  v_add_f32 v144, 0x358637bd, v144
  v_cvt_pk_bf16_f32 v144, 0, v144
  v_rcp_f32 v144, v144
  s_nop 0
  v_mul_f32 v80, v80, v144
  v_mul_f32 v81, v81, v144
  v_mul_f32 v82, v82, v144
  v_mul_f32 v83, v83, v144
  v_mul_f32 v84, v84, v144
  v_mul_f32 v85, v85, v144
  v_mul_f32 v86, v86, v144
  v_mul_f32 v87, v87, v144
  v_mul_f32 v88, v88, v144
  v_mul_f32 v89, v89, v144
  v_mul_f32 v90, v90, v144
  v_mul_f32 v91, v91, v144
  v_mul_f32 v92, v92, v144
  v_mul_f32 v93, v93, v144
  v_mul_f32 v94, v94, v144
  v_mul_f32 v95, v95, v144
  v_mul_f32 v96, v96, v144
  v_mul_f32 v97, v97, v144
  v_mul_f32 v98, v98, v144
  v_mul_f32 v99, v99, v144
  v_mul_f32 v100, v100, v144
  v_mul_f32 v101, v101, v144
  v_mul_f32 v102, v102, v144
  v_mul_f32 v103, v103, v144
  v_mul_f32 v104, v104, v144
  v_mul_f32 v105, v105, v144
  v_mul_f32 v106, v106, v144
  v_mul_f32 v107, v107, v144
  v_mul_f32 v108, v108, v144
  v_mul_f32 v109, v109, v144
  v_mul_f32 v110, v110, v144
  v_mul_f32 v111, v111, v144
  v_cvt_pk_bf16_f32 v160, v80, v81
  v_cvt_pk_bf16_f32 v161, v82, v83
  v_cvt_pk_bf16_f32 v162, v84, v85
  v_cvt_pk_bf16_f32 v163, v86, v87
  v_cvt_pk_bf16_f32 v164, v88, v89
  v_cvt_pk_bf16_f32 v165, v90, v91
  v_cvt_pk_bf16_f32 v166, v92, v93
  v_cvt_pk_bf16_f32 v167, v94, v95
  v_cvt_pk_bf16_f32 v168, v96, v97
  v_cvt_pk_bf16_f32 v169, v98, v99
  v_cvt_pk_bf16_f32 v170, v100, v101
  v_cvt_pk_bf16_f32 v171, v102, v103
  v_cvt_pk_bf16_f32 v172, v104, v105
  v_cvt_pk_bf16_f32 v173, v106, v107
  v_cvt_pk_bf16_f32 v174, v108, v109
  v_cvt_pk_bf16_f32 v175, v110, v111
  s_cmp_lg_u32 s38, 0
  s_cbranch_scc1 L_q_p2x
  s_mov_b32 s63, 0
L_q_p2:
  buffer_load_dword v9, v8, s[24:27], s99 offen sc1
  s_waitcnt vmcnt(0)
  v_cmp_ne_u32 vcc, 0, v9
  s_cmp_eq_u64 vcc, -1
  s_cbranch_scc1 L_q_p2_done
  s_add_u32 s63, s63, 1
  s_cmp_lt_u32 s63, 262144
  s_cbranch_scc1 L_q_p2
  s_branch L_end
L_q_p2_done:
L_q_p2x:
  s_barrier
  s_mov_b32 m0, s60
  s_add_u32 s60, s60, 1024
  buffer_load_dwordx4 v5, s[24:27], s56 offen sc1 lds
  s_add_u32 s56, s56, 1024
  s_mov_b32 m0, s60
  s_add_u32 s60, s60, 1024
  buffer_load_dwordx4 v5, s[24:27], s56 offen sc1 lds
  s_add_u32 s56, s56, 1024
  s_mov_b32 m0, s60
  s_add_u32 s60, s60, 1024
  buffer_load_dwordx4 v5, s[24:27], s56 offen sc1 lds
  s_add_u32 s56, s56, 1024
  s_mov_b32 m0, s60
  s_add_u32 s60, s60, 1024
  buffer_load_dwordx4 v5, s[24:27], s56 offen sc1 lds
  s_add_u32 s56, s56, 1024
  s_mov_b32 m0, s60
  s_add_u32 s60, s60, 1024
  buffer_load_dwordx4 v5, s[24:27], s56 offen sc1 lds
  s_add_u32 s56, s56, 1024
  s_mov_b32 m0, s60
  s_add_u32 s60, s60, 1024
  buffer_load_dwordx4 v5, s[24:27], s56 offen sc1 lds
  s_add_u32 s56, s56, 1024
  s_mov_b32 m0, s60
  s_add_u32 s60, s60, 1024
  buffer_load_dwordx4 v5, s[24:27], s56 offen sc1 lds
  s_add_u32 s56, s56, 1024
  s_mov_b32 m0, s60
  s_add_u32 s60, s60, 1024
  buffer_load_dwordx4 v5, s[24:27], s56 offen sc1 lds
  s_add_u32 s56, s56, 1024
  s_waitcnt vmcnt(4)
  s_barrier
  ds_read_b128 a[0:3], v11 offset:0
  ds_read_b128 a[4:7], v11 offset:8192
  ds_read_b128 a[8:11], v11 offset:16384
  ds_read_b128 a[12:15], v11 offset:24576
  ds_read_b128 a[16:19], v11 offset:1024
  ds_read_b128 a[20:23], v11 offset:9216
  ds_read_b128 a[24:27], v11 offset:17408
  ds_read_b128 a[28:31], v11 offset:25600
  ds_read_b128 a[32:35], v11 offset:2048
  ds_read_b128 a[36:39], v11 offset:10240
  ds_read_b128 a[40:43], v11 offset:18432
  ds_read_b128 a[44:47], v11 offset:26624
  ds_read_b128 a[48:51], v11 offset:3072
  ds_read_b128 a[52:55], v11 offset:11264
  s_waitcnt lgkmcnt(13)
  v_mfma_f32_32x32x16_bf16 v[16:31], v[160:163], a[0:3], 0
  ds_read_b128 a[0:3], v11 offset:19456
  s_waitcnt lgkmcnt(13)
  v_mfma_f32_32x32x16_bf16 v[16:31], v[164:167], a[4:7], v[16:31]
  ds_read_b128 a[4:7], v11 offset:27648
  s_waitcnt lgkmcnt(13)
  v_mfma_f32_32x32x16_bf16 v[16:31], v[168:171], a[8:11], v[16:31]
  s_waitcnt lgkmcnt(12)
  v_mfma_f32_32x32x16_bf16 v[16:31], v[172:175], a[12:15], v[16:31]
  s_waitcnt lgkmcnt(11)
  v_mfma_f32_32x32x16_bf16 v[32:47], v[160:163], a[16:19], 0
  s_waitcnt lgkmcnt(10)
  v_mfma_f32_32x32x16_bf16 v[32:47], v[164:167], a[20:23], v[32:47]
  s_waitcnt lgkmcnt(9)
  v_mfma_f32_32x32x16_bf16 v[32:47], v[168:171], a[24:27], v[32:47]
  s_waitcnt lgkmcnt(8)
  v_mfma_f32_32x32x16_bf16 v[32:47], v[172:175], a[28:31], v[32:47]
  s_waitcnt lgkmcnt(7)
  v_mfma_f32_32x32x16_bf16 v[48:63], v[160:163], a[32:35], 0
  s_waitcnt lgkmcnt(6)
  v_mfma_f32_32x32x16_bf16 v[48:63], v[164:167], a[36:39], v[48:63]
  s_waitcnt vmcnt(0)
  s_barrier
  ds_read_b128 a[8:11], v11 offset:4096
  ds_read_b128 a[12:15], v11 offset:12288
  ds_read_b128 a[16:19], v11 offset:20480
  ds_read_b128 a[20:23], v11 offset:28672
  ds_read_b128 a[24:27], v11 offset:5120
  ds_read_b128 a[28:31], v11 offset:13312
  ds_read_b128 a[32:35], v11 offset:21504
  ds_read_b128 a[36:39], v11 offset:29696
  s_waitcnt lgkmcnt(13)
  v_mfma_f32_32x32x16_bf16 v[48:63], v[168:171], a[40:43], v[48:63]
  ds_read_b128 a[40:43], v11 offset:6144
  s_waitcnt lgkmcnt(13)
  v_mfma_f32_32x32x16_bf16 v[48:63], v[172:175], a[44:47], v[48:63]
  ds_read_b128 a[44:47], v11 offset:14336
  s_waitcnt lgkmcnt(13)
  v_mfma_f32_32x32x16_bf16 v[64:79], v[160:163], a[48:51], 0
  ds_read_b128 a[48:51], v11 offset:22528
  s_waitcnt lgkmcnt(13)
  v_mfma_f32_32x32x16_bf16 v[64:79], v[164:167], a[52:55], v[64:79]
  ds_read_b128 a[52:55], v11 offset:30720
  s_waitcnt lgkmcnt(13)
  v_mfma_f32_32x32x16_bf16 v[64:79], v[168:171], a[0:3], v[64:79]
  ds_read_b128 a[0:3], v11 offset:7168
  s_waitcnt lgkmcnt(13)
  v_mfma_f32_32x32x16_bf16 v[64:79], v[172:175], a[4:7], v[64:79]
  ds_read_b128 a[4:7], v11 offset:15360
  s_waitcnt lgkmcnt(13)
  v_mfma_f32_32x32x16_bf16 v[80:95], v[160:163], a[8:11], 0
  ds_read_b128 a[8:11], v11 offset:23552
  s_waitcnt lgkmcnt(13)
  v_mfma_f32_32x32x16_bf16 v[80:95], v[164:167], a[12:15], v[80:95]
  ds_read_b128 a[12:15], v11 offset:31744
  s_waitcnt lgkmcnt(13)
  v_mfma_f32_32x32x16_bf16 v[80:95], v[168:171], a[16:19], v[80:95]
  s_waitcnt lgkmcnt(12)
  v_mfma_f32_32x32x16_bf16 v[80:95], v[172:175], a[20:23], v[80:95]
  v_cvt_pk_bf16_f32 v176, v16, v32
  v_cvt_pk_bf16_f32 v177, v48, v64
  s_add_u32 s4, s58, 0
  buffer_store_dwordx2 v[176:177], v6, s[20:23], s4 offen offset:0 nt
  v_cvt_pk_bf16_f32 v178, v17, v33
  s_waitcnt lgkmcnt(11)
  v_mfma_f32_32x32x16_bf16 v[96:111], v[160:163], a[24:27], 0
  v_cvt_pk_bf16_f32 v179, v49, v65
  buffer_store_dwordx2 v[178:179], v6, s[20:23], s4 offen offset:512 nt
  v_cvt_pk_bf16_f32 v180, v18, v34
  v_cvt_pk_bf16_f32 v181, v50, v66
  buffer_store_dwordx2 v[180:181], v6, s[20:23], s4 offen offset:1024 nt
  s_waitcnt lgkmcnt(10)
  v_mfma_f32_32x32x16_bf16 v[96:111], v[164:167], a[28:31], v[96:111]
  v_cvt_pk_bf16_f32 v182, v19, v35
  v_cvt_pk_bf16_f32 v183, v51, v67
  buffer_store_dwordx2 v[182:183], v6, s[20:23], s4 offen offset:1536 nt
  v_cvt_pk_bf16_f32 v176, v20, v36
  v_cvt_pk_bf16_f32 v177, v52, v68
  s_waitcnt lgkmcnt(9)
  v_mfma_f32_32x32x16_bf16 v[96:111], v[168:171], a[32:35], v[96:111]
  s_add_u32 s4, s58, 4096
  buffer_store_dwordx2 v[176:177], v6, s[20:23], s4 offen offset:0 nt
  v_cvt_pk_bf16_f32 v178, v21, v37
  v_cvt_pk_bf16_f32 v179, v53, v69
  buffer_store_dwordx2 v[178:179], v6, s[20:23], s4 offen offset:512 nt
  s_waitcnt lgkmcnt(8)
  v_mfma_f32_32x32x16_bf16 v[96:111], v[172:175], a[36:39], v[96:111]
  v_cvt_pk_bf16_f32 v180, v22, v38
  v_cvt_pk_bf16_f32 v181, v54, v70
  buffer_store_dwordx2 v[180:181], v6, s[20:23], s4 offen offset:1024 nt
  v_cvt_pk_bf16_f32 v182, v23, v39
  v_cvt_pk_bf16_f32 v183, v55, v71
  s_waitcnt lgkmcnt(7)
  v_mfma_f32_32x32x16_bf16 v[112:127], v[160:163], a[40:43], 0
  buffer_store_dwordx2 v[182:183], v6, s[20:23], s4 offen offset:1536 nt
  v_cvt_pk_bf16_f32 v176, v24, v40
  v_cvt_pk_bf16_f32 v177, v56, v72
  s_add_u32 s4, s58, 8192
  buffer_store_dwordx2 v[176:177], v6, s[20:23], s4 offen offset:0 nt
  s_waitcnt lgkmcnt(6)
  v_mfma_f32_32x32x16_bf16 v[112:127], v[164:167], a[44:47], v[112:127]
  v_cvt_pk_bf16_f32 v178, v25, v41
  v_cvt_pk_bf16_f32 v179, v57, v73
  buffer_store_dwordx2 v[178:179], v6, s[20:23], s4 offen offset:512 nt
  v_cvt_pk_bf16_f32 v180, v26, v42
  v_cvt_pk_bf16_f32 v181, v58, v74
  s_waitcnt lgkmcnt(5)
  v_mfma_f32_32x32x16_bf16 v[112:127], v[168:171], a[48:51], v[112:127]
  buffer_store_dwordx2 v[180:181], v6, s[20:23], s4 offen offset:1024 nt
  v_cvt_pk_bf16_f32 v182, v27, v43
  v_cvt_pk_bf16_f32 v183, v59, v75
  buffer_store_dwordx2 v[182:183], v6, s[20:23], s4 offen offset:1536 nt
  v_cvt_pk_bf16_f32 v176, v28, v44
  s_waitcnt lgkmcnt(4)
  v_mfma_f32_32x32x16_bf16 v[112:127], v[172:175], a[52:55], v[112:127]
  v_cvt_pk_bf16_f32 v177, v60, v76
  s_add_u32 s4, s58, 12288
  buffer_store_dwordx2 v[176:177], v6, s[20:23], s4 offen offset:0 nt
  v_cvt_pk_bf16_f32 v178, v29, v45
  v_cvt_pk_bf16_f32 v179, v61, v77
  s_waitcnt lgkmcnt(3)
  v_mfma_f32_32x32x16_bf16 v[128:143], v[160:163], a[0:3], 0
  buffer_store_dwordx2 v[178:179], v6, s[20:23], s4 offen offset:512 nt
  v_cvt_pk_bf16_f32 v180, v30, v46
  v_cvt_pk_bf16_f32 v181, v62, v78
  buffer_store_dwordx2 v[180:181], v6, s[20:23], s4 offen offset:1024 nt
  v_cvt_pk_bf16_f32 v182, v31, v47
  s_waitcnt lgkmcnt(2)
  v_mfma_f32_32x32x16_bf16 v[128:143], v[164:167], a[4:7], v[128:143]
  v_cvt_pk_bf16_f32 v183, v63, v79
  buffer_store_dwordx2 v[182:183], v6, s[20:23], s4 offen offset:1536 nt
  s_waitcnt lgkmcnt(1)
  v_mfma_f32_32x32x16_bf16 v[128:143], v[168:171], a[8:11], v[128:143]
  s_waitcnt lgkmcnt(0)
  v_mfma_f32_32x32x16_bf16 v[128:143], v[172:175], a[12:15], v[128:143]
  s_nop 14
  v_cvt_pk_bf16_f32 v176, v80, v96
  v_cvt_pk_bf16_f32 v177, v112, v128
  s_add_u32 s4, s58, 256
  buffer_store_dwordx2 v[176:177], v6, s[20:23], s4 offen offset:0 nt
  v_cvt_pk_bf16_f32 v178, v81, v97
  v_cvt_pk_bf16_f32 v179, v113, v129
  buffer_store_dwordx2 v[178:179], v6, s[20:23], s4 offen offset:512 nt
  v_cvt_pk_bf16_f32 v180, v82, v98
  v_cvt_pk_bf16_f32 v181, v114, v130
  buffer_store_dwordx2 v[180:181], v6, s[20:23], s4 offen offset:1024 nt
  v_cvt_pk_bf16_f32 v182, v83, v99
  v_cvt_pk_bf16_f32 v183, v115, v131
  buffer_store_dwordx2 v[182:183], v6, s[20:23], s4 offen offset:1536 nt
  v_cvt_pk_bf16_f32 v176, v84, v100
  v_cvt_pk_bf16_f32 v177, v116, v132
  s_add_u32 s4, s58, 4352
  buffer_store_dwordx2 v[176:177], v6, s[20:23], s4 offen offset:0 nt
  v_cvt_pk_bf16_f32 v178, v85, v101
  v_cvt_pk_bf16_f32 v179, v117, v133
  buffer_store_dwordx2 v[178:179], v6, s[20:23], s4 offen offset:512 nt
  v_cvt_pk_bf16_f32 v180, v86, v102
  v_cvt_pk_bf16_f32 v181, v118, v134
  buffer_store_dwordx2 v[180:181], v6, s[20:23], s4 offen offset:1024 nt
  v_cvt_pk_bf16_f32 v182, v87, v103
  v_cvt_pk_bf16_f32 v183, v119, v135
  buffer_store_dwordx2 v[182:183], v6, s[20:23], s4 offen offset:1536 nt
  v_cvt_pk_bf16_f32 v176, v88, v104
  v_cvt_pk_bf16_f32 v177, v120, v136
  s_add_u32 s4, s58, 8448
  buffer_store_dwordx2 v[176:177], v6, s[20:23], s4 offen offset:0 nt
  v_cvt_pk_bf16_f32 v178, v89, v105
  v_cvt_pk_bf16_f32 v179, v121, v137
  buffer_store_dwordx2 v[178:179], v6, s[20:23], s4 offen offset:512 nt
  v_cvt_pk_bf16_f32 v180, v90, v106
  v_cvt_pk_bf16_f32 v181, v122, v138
  buffer_store_dwordx2 v[180:181], v6, s[20:23], s4 offen offset:1024 nt
  v_cvt_pk_bf16_f32 v182, v91, v107
  v_cvt_pk_bf16_f32 v183, v123, v139
  buffer_store_dwordx2 v[182:183], v6, s[20:23], s4 offen offset:1536 nt
  v_cvt_pk_bf16_f32 v176, v92, v108
  v_cvt_pk_bf16_f32 v177, v124, v140
  s_add_u32 s4, s58, 12544
  buffer_store_dwordx2 v[176:177], v6, s[20:23], s4 offen offset:0 nt
  v_cvt_pk_bf16_f32 v178, v93, v109
  v_cvt_pk_bf16_f32 v179, v125, v141
  buffer_store_dwordx2 v[178:179], v6, s[20:23], s4 offen offset:512 nt
  v_cvt_pk_bf16_f32 v180, v94, v110
  v_cvt_pk_bf16_f32 v181, v126, v142
  buffer_store_dwordx2 v[180:181], v6, s[20:23], s4 offen offset:1024 nt
  v_cvt_pk_bf16_f32 v182, v95, v111
  v_cvt_pk_bf16_f32 v183, v127, v143
  buffer_store_dwordx2 v[182:183], v6, s[20:23], s4 offen offset:1536 nt
L_end:
  s_endpgm
.section .rodata,"a"
.p2align 6
.amdhsa_kernel standalone__linear_kernel_rfa__prompt_kernel
  .amdhsa_next_free_vgpr 256
  .amdhsa_next_free_sgpr 102
  .amdhsa_accum_offset 192
  .amdhsa_group_segment_fixed_size 0
  .amdhsa_kernarg_size 56
  .amdhsa_user_sgpr_count 2
  .amdhsa_user_sgpr_kernarg_segment_ptr 1
  .amdhsa_system_sgpr_workgroup_id_x 1
  .amdhsa_float_denorm_mode_32 3
.end_amdhsa_kernel
```
